```python
import torch

def _softmax(x, axis=-1):
    return torch.softmax(x, dim=axis)

def _gelu(x):
    return torch.nn.functional.gelu(x, approximate='tanh')

def _silu(x):
    return torch.nn.functional.silu(x)

def _sigmoid(x):
    return torch.sigmoid(x)

def _layernorm(x, axis=-1, eps=1e-05):
    m = x.mean(dim=axis, keepdim=True)
    v = x.var(dim=axis, keepdim=True, unbiased=False)
    return (x - m) / torch.sqrt(v + eps)

def _scatter_add(tgt, idx, src, axis=0):
    return tgt.clone().index_add_(axis, idx, src)

def _segment_sum(src, seg, n):
    out = torch.zeros((n,) + src.shape[1:], dtype=src.dtype)
    return out.index_add_(0, seg, src)

def _pad(x, pw):
    flat = tuple((v for pair in reversed(pw) for v in pair))
    return torch.nn.functional.pad(x, flat)
kernel_name = 'parallel_sum__grouped_kv_mqa__mixer_gmlp__prompt'

def setup_inputs():

    _w = lambda a: (lambda t: t.to(torch.bfloat16) if t.is_floating_point() else t)(torch.as_tensor(a))

    def _A_setup():
        B, S, D, H = (1, 2048, 576, 32)
        Dh = D // H
        return {'x': _w((lambda *s: torch.randn(*s, dtype=torch.bfloat16) * 0.05)(B, S, D)), 'wq': _w((lambda *s: torch.randn(*s, dtype=torch.bfloat16) * 0.2)(D, H * Dh)), 'wk': _w((lambda *s: torch.randn(*s, dtype=torch.bfloat16) * 0.2)(D, Dh)), 'wv': _w((lambda *s: torch.randn(*s, dtype=torch.bfloat16) * 0.1)(D, Dh)), 'wo': _w((lambda *s: torch.randn(*s, dtype=torch.bfloat16) * 0.1)(H * Dh, D))}
    _A_in = _A_setup()

    def _B_setup():
        B, S, D, F = (1, 2048, 576, 4608)
        Fh = F // 2
        return {'x': _w((lambda *s: torch.randn(*s, dtype=torch.bfloat16) * 0.05)(B, S, D)), 'w_in': _w((lambda *s: torch.randn(*s, dtype=torch.bfloat16) * 0.4)(D, 2 * Fh)), 'w_sp': _w(0.01 * (lambda *s: torch.randn(*s, dtype=torch.bfloat16) * 0.4)(S, S)), 'b_sp': _w(1.0 + 0.01 * (lambda *s: torch.randn(*s, dtype=torch.bfloat16) * 0.1)(S)), 'w_out': _w((lambda *s: torch.randn(*s, dtype=torch.bfloat16) * 0.1)(Fh, D))}
    _B_in = _B_setup()
    return {'A_x': _A_in['x'], 'A_wq': _A_in['wq'], 'A_wk': _A_in['wk'], 'A_wv': _A_in['wv'], 'A_wo': _A_in['wo'], 'B_x': _B_in['x'], 'B_w_in': _B_in['w_in'], 'B_w_sp': _B_in['w_sp'], 'B_b_sp': _B_in['b_sp'], 'B_w_out': _B_in['w_out']}

def reference(A_x, A_wq, A_wk, A_wv, A_wo, B_x, B_w_in, B_w_sp, B_b_sp, B_w_out):

    def _A_ref(x, wq, wk, wv, wo):
        B, S, D = x.shape
        H = 32
        Dh = D // H
        q = (lambda x, *d: x.permute(*d))((x @ wq).reshape(B, S, H, Dh), 0, 2, 1, 3)
        k = x @ wk
        v = x @ wv
        scores = torch.einsum('bhqd,bkd->bhqk', q, k) * Dh ** (-0.5)
        p = _softmax(scores, axis=-1)
        o = torch.einsum('bhqk,bkd->bhqd', p, v)
        return (lambda x, *d: x.permute(*d))(o, 0, 2, 1, 3).reshape(B, S, H * Dh) @ wo

    def _B_ref(x, w_in, w_sp, b_sp, w_out):
        B, S, D = x.shape
        F = w_in.shape[-1]
        Fh = F // 2
        z = _gelu(torch.einsum('bsd,df->bsf', x, w_in))
        z1 = z[..., :Fh].clone()
        z2 = _layernorm(z[..., Fh:], axis=-1)
        g = torch.einsum('ts,bsf->btf', w_sp, z2) + b_sp[None, :, None]
        return torch.einsum('bsf,fd->bsd', z1 * g, w_out)
    x = A_x
    xn = _layernorm(x, axis=-1)
    return x + _A_ref(xn, A_wq, A_wk, A_wv, A_wo) + _B_ref(xn, B_w_in, B_w_sp, B_b_sp, B_w_out)
```

```asm
; @launch kernel=prep_kernel grid=(312,1,1) block=(256,1,1) lds=0
; @launch kernel=gemm1_kernel grid=(232,1,1) block=(640,1,1) lds=161792
; @launch kernel=attn_kernel grid=(256,1,1) block=(1024,1,1) lds=163840
; @launch kernel=gemm2_kernel grid=(256,1,1) block=(384,1,1) lds=141312
; @launch kernel=gemm3_kernel grid=(192,1,1) block=(384,1,1) lds=122880
.amdgcn_target "amdgcn-amd-amdhsa--gfx950"
.text
.globl prep_kernel
.p2align 8
.type prep_kernel,@function
prep_kernel:
    s_load_dwordx2 s[4:5], s[0:1], 0
    s_load_dwordx2 s[6:7], s[0:1], 16
    s_load_dwordx2 s[8:9], s[0:1], 24
    s_load_dwordx2 s[10:11], s[0:1], 96
    s_load_dwordx2 s[24:25], s[0:1], 48
    s_load_dwordx2 s[26:27], s[0:1], 8
    s_load_dwordx2 s[28:29], s[0:1], 56
    s_load_dwordx2 s[30:31], s[0:1], 72
    s_load_dwordx2 s[32:33], s[0:1], 32
    s_cmp_ge_u32 s2, 312
    s_cbranch_scc1 prep_done
    s_waitcnt lgkmcnt(0)
    s_cmp_ge_u32 s2, 128
    s_cbranch_scc1 prep_pf

    s_mov_b32 s12, s4
    s_and_b32 s13, s5, 0xffff
    s_mov_b32 s14, 0x240000
    s_mov_b32 s15, 0x00020000
    s_mov_b32 s16, s10
    s_and_b32 s17, s11, 0xffff
    s_mov_b32 s18, 0x240000
    s_mov_b32 s19, 0x00020000
    v_lshrrev_b32 v1, 4, v0
    s_lshl_b32 s3, s2, 4
    v_add_u32 v1, s3, v1
    v_mul_u32_u24 v1, 1152, v1
    v_and_b32 v2, 15, v0
    v_lshl_add_u32 v1, v2, 3, v1

    buffer_load_dwordx2 v[60:61], v1, s[12:15], 0 offen offset:0
    buffer_load_dwordx2 v[62:63], v1, s[12:15], 0 offen offset:128
    buffer_load_dwordx2 v[64:65], v1, s[12:15], 0 offen offset:256
    buffer_load_dwordx2 v[66:67], v1, s[12:15], 0 offen offset:384
    buffer_load_dwordx2 v[68:69], v1, s[12:15], 0 offen offset:512
    buffer_load_dwordx2 v[70:71], v1, s[12:15], 0 offen offset:640
    buffer_load_dwordx2 v[72:73], v1, s[12:15], 0 offen offset:768
    buffer_load_dwordx2 v[74:75], v1, s[12:15], 0 offen offset:896
    buffer_load_dwordx2 v[76:77], v1, s[12:15], 0 offen offset:1024
    s_waitcnt vmcnt(0)
    v_lshlrev_b32 v20, 16, v60
    v_and_b32 v21, 0xffff0000, v60
    v_lshlrev_b32 v22, 16, v61
    v_and_b32 v23, 0xffff0000, v61
    v_lshlrev_b32 v24, 16, v62
    v_and_b32 v25, 0xffff0000, v62
    v_lshlrev_b32 v26, 16, v63
    v_and_b32 v27, 0xffff0000, v63
    v_lshlrev_b32 v28, 16, v64
    v_and_b32 v29, 0xffff0000, v64
    v_lshlrev_b32 v30, 16, v65
    v_and_b32 v31, 0xffff0000, v65
    v_lshlrev_b32 v32, 16, v66
    v_and_b32 v33, 0xffff0000, v66
    v_lshlrev_b32 v34, 16, v67
    v_and_b32 v35, 0xffff0000, v67
    v_lshlrev_b32 v36, 16, v68
    v_and_b32 v37, 0xffff0000, v68
    v_lshlrev_b32 v38, 16, v69
    v_and_b32 v39, 0xffff0000, v69
    v_lshlrev_b32 v40, 16, v70
    v_and_b32 v41, 0xffff0000, v70
    v_lshlrev_b32 v42, 16, v71
    v_and_b32 v43, 0xffff0000, v71
    v_lshlrev_b32 v44, 16, v72
    v_and_b32 v45, 0xffff0000, v72
    v_lshlrev_b32 v46, 16, v73
    v_and_b32 v47, 0xffff0000, v73
    v_lshlrev_b32 v48, 16, v74
    v_and_b32 v49, 0xffff0000, v74
    v_lshlrev_b32 v50, 16, v75
    v_and_b32 v51, 0xffff0000, v75
    v_lshlrev_b32 v52, 16, v76
    v_and_b32 v53, 0xffff0000, v76
    v_lshlrev_b32 v54, 16, v77
    v_and_b32 v55, 0xffff0000, v77
    v_add_f32 v4, v20, v21
    v_add_f32 v4, v4, v22
    v_add_f32 v4, v4, v23
    v_add_f32 v4, v4, v24
    v_add_f32 v4, v4, v25
    v_add_f32 v4, v4, v26
    v_add_f32 v4, v4, v27
    v_add_f32 v4, v4, v28
    v_add_f32 v4, v4, v29
    v_add_f32 v4, v4, v30
    v_add_f32 v4, v4, v31
    v_add_f32 v4, v4, v32
    v_add_f32 v4, v4, v33
    v_add_f32 v4, v4, v34
    v_add_f32 v4, v4, v35
    v_add_f32 v4, v4, v36
    v_add_f32 v4, v4, v37
    v_add_f32 v4, v4, v38
    v_add_f32 v4, v4, v39
    v_add_f32 v4, v4, v40
    v_add_f32 v4, v4, v41
    v_add_f32 v4, v4, v42
    v_add_f32 v4, v4, v43
    v_add_f32 v4, v4, v44
    v_add_f32 v4, v4, v45
    v_add_f32 v4, v4, v46
    v_add_f32 v4, v4, v47
    v_add_f32 v4, v4, v48
    v_add_f32 v4, v4, v49
    v_add_f32 v4, v4, v50
    v_add_f32 v4, v4, v51
    v_add_f32 v4, v4, v52
    v_add_f32 v4, v4, v53
    v_add_f32 v4, v4, v54
    v_add_f32 v4, v4, v55
    s_nop 1
    v_add_f32_dpp v5, v4, v4 row_ror:8 row_mask:0xf bank_mask:0xf
    v_mov_b32 v4, v5
    s_nop 1
    v_add_f32_dpp v5, v4, v4 row_ror:4 row_mask:0xf bank_mask:0xf
    v_mov_b32 v4, v5
    s_nop 1
    v_add_f32_dpp v5, v4, v4 row_ror:2 row_mask:0xf bank_mask:0xf
    v_mov_b32 v4, v5
    s_nop 1
    v_add_f32_dpp v5, v4, v4 row_ror:1 row_mask:0xf bank_mask:0xf
    v_mov_b32 v4, v5
    v_mul_f32 v6, 0x3ae38e39, v4
    v_sub_f32 v5, v20, v6
    v_mul_f32 v4, v5, v5
    v_sub_f32 v5, v21, v6
    v_fmac_f32 v4, v5, v5
    v_sub_f32 v5, v22, v6
    v_fmac_f32 v4, v5, v5
    v_sub_f32 v5, v23, v6
    v_fmac_f32 v4, v5, v5
    v_sub_f32 v5, v24, v6
    v_fmac_f32 v4, v5, v5
    v_sub_f32 v5, v25, v6
    v_fmac_f32 v4, v5, v5
    v_sub_f32 v5, v26, v6
    v_fmac_f32 v4, v5, v5
    v_sub_f32 v5, v27, v6
    v_fmac_f32 v4, v5, v5
    v_sub_f32 v5, v28, v6
    v_fmac_f32 v4, v5, v5
    v_sub_f32 v5, v29, v6
    v_fmac_f32 v4, v5, v5
    v_sub_f32 v5, v30, v6
    v_fmac_f32 v4, v5, v5
    v_sub_f32 v5, v31, v6
    v_fmac_f32 v4, v5, v5
    v_sub_f32 v5, v32, v6
    v_fmac_f32 v4, v5, v5
    v_sub_f32 v5, v33, v6
    v_fmac_f32 v4, v5, v5
    v_sub_f32 v5, v34, v6
    v_fmac_f32 v4, v5, v5
    v_sub_f32 v5, v35, v6
    v_fmac_f32 v4, v5, v5
    v_sub_f32 v5, v36, v6
    v_fmac_f32 v4, v5, v5
    v_sub_f32 v5, v37, v6
    v_fmac_f32 v4, v5, v5
    v_sub_f32 v5, v38, v6
    v_fmac_f32 v4, v5, v5
    v_sub_f32 v5, v39, v6
    v_fmac_f32 v4, v5, v5
    v_sub_f32 v5, v40, v6
    v_fmac_f32 v4, v5, v5
    v_sub_f32 v5, v41, v6
    v_fmac_f32 v4, v5, v5
    v_sub_f32 v5, v42, v6
    v_fmac_f32 v4, v5, v5
    v_sub_f32 v5, v43, v6
    v_fmac_f32 v4, v5, v5
    v_sub_f32 v5, v44, v6
    v_fmac_f32 v4, v5, v5
    v_sub_f32 v5, v45, v6
    v_fmac_f32 v4, v5, v5
    v_sub_f32 v5, v46, v6
    v_fmac_f32 v4, v5, v5
    v_sub_f32 v5, v47, v6
    v_fmac_f32 v4, v5, v5
    v_sub_f32 v5, v48, v6
    v_fmac_f32 v4, v5, v5
    v_sub_f32 v5, v49, v6
    v_fmac_f32 v4, v5, v5
    v_sub_f32 v5, v50, v6
    v_fmac_f32 v4, v5, v5
    v_sub_f32 v5, v51, v6
    v_fmac_f32 v4, v5, v5
    v_sub_f32 v5, v52, v6
    v_fmac_f32 v4, v5, v5
    v_sub_f32 v5, v53, v6
    v_fmac_f32 v4, v5, v5
    v_sub_f32 v5, v54, v6
    v_fmac_f32 v4, v5, v5
    v_sub_f32 v5, v55, v6
    v_fmac_f32 v4, v5, v5
    s_nop 1
    v_add_f32_dpp v5, v4, v4 row_ror:8 row_mask:0xf bank_mask:0xf
    v_mov_b32 v4, v5
    s_nop 1
    v_add_f32_dpp v5, v4, v4 row_ror:4 row_mask:0xf bank_mask:0xf
    v_mov_b32 v4, v5
    s_nop 1
    v_add_f32_dpp v5, v4, v4 row_ror:2 row_mask:0xf bank_mask:0xf
    v_mov_b32 v4, v5
    s_nop 1
    v_add_f32_dpp v5, v4, v4 row_ror:1 row_mask:0xf bank_mask:0xf
    v_mov_b32 v4, v5
    v_mul_f32 v4, 0x3ae38e39, v4
    v_cvt_pk_bf16_f32 v4, v4, v4
    v_lshlrev_b32 v4, 16, v4
    v_add_f32 v4, 0x3727c5ac, v4
    v_cvt_pk_bf16_f32 v4, v4, v4
    v_lshlrev_b32 v4, 16, v4
    v_sqrt_f32 v4, v4
    s_nop 0
    v_cvt_pk_bf16_f32 v4, v4, v4
    v_lshlrev_b32 v4, 16, v4
    v_rcp_f32 v7, v4
    v_cvt_pk_bf16_f32 v6, v6, v6
    v_lshlrev_b32 v6, 16, v6
    v_sub_f32 v20, v20, v6
    v_sub_f32 v21, v21, v6
    v_cvt_pk_bf16_f32 v60, v20, v21
    v_lshlrev_b32 v20, 16, v60
    v_and_b32 v21, 0xffff0000, v60
    v_mul_f32 v20, v20, v7
    v_mul_f32 v21, v21, v7
    v_cvt_pk_bf16_f32 v60, v20, v21
    v_sub_f32 v22, v22, v6
    v_sub_f32 v23, v23, v6
    v_cvt_pk_bf16_f32 v61, v22, v23
    v_lshlrev_b32 v22, 16, v61
    v_and_b32 v23, 0xffff0000, v61
    v_mul_f32 v22, v22, v7
    v_mul_f32 v23, v23, v7
    v_cvt_pk_bf16_f32 v61, v22, v23
    v_sub_f32 v24, v24, v6
    v_sub_f32 v25, v25, v6
    v_cvt_pk_bf16_f32 v62, v24, v25
    v_lshlrev_b32 v24, 16, v62
    v_and_b32 v25, 0xffff0000, v62
    v_mul_f32 v24, v24, v7
    v_mul_f32 v25, v25, v7
    v_cvt_pk_bf16_f32 v62, v24, v25
    v_sub_f32 v26, v26, v6
    v_sub_f32 v27, v27, v6
    v_cvt_pk_bf16_f32 v63, v26, v27
    v_lshlrev_b32 v26, 16, v63
    v_and_b32 v27, 0xffff0000, v63
    v_mul_f32 v26, v26, v7
    v_mul_f32 v27, v27, v7
    v_cvt_pk_bf16_f32 v63, v26, v27
    v_sub_f32 v28, v28, v6
    v_sub_f32 v29, v29, v6
    v_cvt_pk_bf16_f32 v64, v28, v29
    v_lshlrev_b32 v28, 16, v64
    v_and_b32 v29, 0xffff0000, v64
    v_mul_f32 v28, v28, v7
    v_mul_f32 v29, v29, v7
    v_cvt_pk_bf16_f32 v64, v28, v29
    v_sub_f32 v30, v30, v6
    v_sub_f32 v31, v31, v6
    v_cvt_pk_bf16_f32 v65, v30, v31
    v_lshlrev_b32 v30, 16, v65
    v_and_b32 v31, 0xffff0000, v65
    v_mul_f32 v30, v30, v7
    v_mul_f32 v31, v31, v7
    v_cvt_pk_bf16_f32 v65, v30, v31
    v_sub_f32 v32, v32, v6
    v_sub_f32 v33, v33, v6
    v_cvt_pk_bf16_f32 v66, v32, v33
    v_lshlrev_b32 v32, 16, v66
    v_and_b32 v33, 0xffff0000, v66
    v_mul_f32 v32, v32, v7
    v_mul_f32 v33, v33, v7
    v_cvt_pk_bf16_f32 v66, v32, v33
    v_sub_f32 v34, v34, v6
    v_sub_f32 v35, v35, v6
    v_cvt_pk_bf16_f32 v67, v34, v35
    v_lshlrev_b32 v34, 16, v67
    v_and_b32 v35, 0xffff0000, v67
    v_mul_f32 v34, v34, v7
    v_mul_f32 v35, v35, v7
    v_cvt_pk_bf16_f32 v67, v34, v35
    v_sub_f32 v36, v36, v6
    v_sub_f32 v37, v37, v6
    v_cvt_pk_bf16_f32 v68, v36, v37
    v_lshlrev_b32 v36, 16, v68
    v_and_b32 v37, 0xffff0000, v68
    v_mul_f32 v36, v36, v7
    v_mul_f32 v37, v37, v7
    v_cvt_pk_bf16_f32 v68, v36, v37
    v_sub_f32 v38, v38, v6
    v_sub_f32 v39, v39, v6
    v_cvt_pk_bf16_f32 v69, v38, v39
    v_lshlrev_b32 v38, 16, v69
    v_and_b32 v39, 0xffff0000, v69
    v_mul_f32 v38, v38, v7
    v_mul_f32 v39, v39, v7
    v_cvt_pk_bf16_f32 v69, v38, v39
    v_sub_f32 v40, v40, v6
    v_sub_f32 v41, v41, v6
    v_cvt_pk_bf16_f32 v70, v40, v41
    v_lshlrev_b32 v40, 16, v70
    v_and_b32 v41, 0xffff0000, v70
    v_mul_f32 v40, v40, v7
    v_mul_f32 v41, v41, v7
    v_cvt_pk_bf16_f32 v70, v40, v41
    v_sub_f32 v42, v42, v6
    v_sub_f32 v43, v43, v6
    v_cvt_pk_bf16_f32 v71, v42, v43
    v_lshlrev_b32 v42, 16, v71
    v_and_b32 v43, 0xffff0000, v71
    v_mul_f32 v42, v42, v7
    v_mul_f32 v43, v43, v7
    v_cvt_pk_bf16_f32 v71, v42, v43
    v_sub_f32 v44, v44, v6
    v_sub_f32 v45, v45, v6
    v_cvt_pk_bf16_f32 v72, v44, v45
    v_lshlrev_b32 v44, 16, v72
    v_and_b32 v45, 0xffff0000, v72
    v_mul_f32 v44, v44, v7
    v_mul_f32 v45, v45, v7
    v_cvt_pk_bf16_f32 v72, v44, v45
    v_sub_f32 v46, v46, v6
    v_sub_f32 v47, v47, v6
    v_cvt_pk_bf16_f32 v73, v46, v47
    v_lshlrev_b32 v46, 16, v73
    v_and_b32 v47, 0xffff0000, v73
    v_mul_f32 v46, v46, v7
    v_mul_f32 v47, v47, v7
    v_cvt_pk_bf16_f32 v73, v46, v47
    v_sub_f32 v48, v48, v6
    v_sub_f32 v49, v49, v6
    v_cvt_pk_bf16_f32 v74, v48, v49
    v_lshlrev_b32 v48, 16, v74
    v_and_b32 v49, 0xffff0000, v74
    v_mul_f32 v48, v48, v7
    v_mul_f32 v49, v49, v7
    v_cvt_pk_bf16_f32 v74, v48, v49
    v_sub_f32 v50, v50, v6
    v_sub_f32 v51, v51, v6
    v_cvt_pk_bf16_f32 v75, v50, v51
    v_lshlrev_b32 v50, 16, v75
    v_and_b32 v51, 0xffff0000, v75
    v_mul_f32 v50, v50, v7
    v_mul_f32 v51, v51, v7
    v_cvt_pk_bf16_f32 v75, v50, v51
    v_sub_f32 v52, v52, v6
    v_sub_f32 v53, v53, v6
    v_cvt_pk_bf16_f32 v76, v52, v53
    v_lshlrev_b32 v52, 16, v76
    v_and_b32 v53, 0xffff0000, v76
    v_mul_f32 v52, v52, v7
    v_mul_f32 v53, v53, v7
    v_cvt_pk_bf16_f32 v76, v52, v53
    v_sub_f32 v54, v54, v6
    v_sub_f32 v55, v55, v6
    v_cvt_pk_bf16_f32 v77, v54, v55
    v_lshlrev_b32 v54, 16, v77
    v_and_b32 v55, 0xffff0000, v77
    v_mul_f32 v54, v54, v7
    v_mul_f32 v55, v55, v7
    v_cvt_pk_bf16_f32 v77, v54, v55
    buffer_store_dwordx2 v[60:61], v1, s[16:19], 0 offen offset:0
    buffer_store_dwordx2 v[62:63], v1, s[16:19], 0 offen offset:128
    buffer_store_dwordx2 v[64:65], v1, s[16:19], 0 offen offset:256
    buffer_store_dwordx2 v[66:67], v1, s[16:19], 0 offen offset:384
    buffer_store_dwordx2 v[68:69], v1, s[16:19], 0 offen offset:512
    buffer_store_dwordx2 v[70:71], v1, s[16:19], 0 offen offset:640
    buffer_store_dwordx2 v[72:73], v1, s[16:19], 0 offen offset:768
    buffer_store_dwordx2 v[74:75], v1, s[16:19], 0 offen offset:896
    buffer_store_dwordx2 v[76:77], v1, s[16:19], 0 offen offset:1024
    s_endpgm
prep_pf:
    s_mov_b32 s12, s24
    s_and_b32 s13, s25, 0xffff
    s_mov_b32 s14, 0x510000
    s_mov_b32 s15, 0x00020000
    s_sub_u32 s3, s2, 128
    s_cmp_ge_u32 s3, 162
    s_cselect_b32 s12, s26, s12
    s_cselect_b32 s13, s27, s13
    s_cselect_b32 s14, 663552, s14
    s_cselect_b32 s20, 162, 0
    s_and_b32 s13, s13, 0xffff
    s_sub_u32 s3, s3, s20
    s_lshl_b32 s3, s3, 15
    v_lshlrev_b32 v1, 4, v0

    s_add_u32 s21, s3, 0
    buffer_load_dwordx4 v[4:7], v1, s[12:15], s21 offen
    s_add_u32 s21, s3, 4096
    buffer_load_dwordx4 v[8:11], v1, s[12:15], s21 offen
    s_add_u32 s21, s3, 8192
    buffer_load_dwordx4 v[12:15], v1, s[12:15], s21 offen
    s_add_u32 s21, s3, 12288
    buffer_load_dwordx4 v[16:19], v1, s[12:15], s21 offen
    s_add_u32 s21, s3, 16384
    buffer_load_dwordx4 v[20:23], v1, s[12:15], s21 offen
    s_add_u32 s21, s3, 20480
    buffer_load_dwordx4 v[24:27], v1, s[12:15], s21 offen
    s_add_u32 s21, s3, 24576
    buffer_load_dwordx4 v[28:31], v1, s[12:15], s21 offen
    s_add_u32 s21, s3, 28672
    buffer_load_dwordx4 v[32:35], v1, s[12:15], s21 offen
    s_waitcnt vmcnt(0)
prep_done:
    s_endpgm
.section .rodata,"a"
.p2align 6
.amdhsa_kernel prep_kernel
  .amdhsa_next_free_vgpr 80
  .amdhsa_next_free_sgpr 40
  .amdhsa_accum_offset 80
  .amdhsa_group_segment_fixed_size 0
  .amdhsa_kernarg_size 104
  .amdhsa_user_sgpr_count 2
  .amdhsa_user_sgpr_kernarg_segment_ptr 1
  .amdhsa_system_sgpr_workgroup_id_x 1
.end_amdhsa_kernel
.text
.globl gemm1_kernel
.p2align 8
.type gemm1_kernel,@function
gemm1_kernel:
    s_load_dwordx2 s[4:5], s[0:1], 8
    s_load_dwordx2 s[6:7], s[0:1], 48
    s_load_dwordx2 s[10:11], s[0:1], 96
    s_load_dwordx2 s[8:9], s[0:1], 0
    s_load_dwordx4 s[48:51], s[0:1], 16
    s_load_dwordx2 s[52:53], s[0:1], 56
    s_load_dwordx2 s[54:55], s[0:1], 72
    s_load_dwordx2 s[56:57], s[0:1], 32
    s_cmp_ge_u32 s2, 232
    s_cbranch_scc1 g1_done
    s_and_b32 s36, s2, 7
    s_lshr_b32 s37, s2, 3
    s_mul_i32 s36, s36, 29
    s_add_u32 s36, s36, s37
    s_and_b32 s28, s36, 7
    s_lshr_b32 s29, s36, 3
    s_waitcnt lgkmcnt(0)

    s_mov_b32 s12, s10
    s_and_b32 s13, s11, 0xffff
    s_mov_b32 s14, 0x240000
    s_mov_b32 s15, 0x00020000
    s_mov_b32 s24, s50
    s_and_b32 s25, s51, 0xffff
    s_mov_b32 s26, 0x5100
    s_mov_b32 s27, 0x00020000
    s_mov_b32 s47, 0
    s_cmp_lt_u32 s29, 3
    s_cbranch_scc1 g1_bq
    s_cmp_lt_u32 s29, 27
    s_cbranch_scc1 g1_bz

    s_cmp_eq_u32 s29, 28
    s_cselect_b32 s48, s50, s48
    s_cselect_b32 s49, s51, s49
    s_mov_b32 s16, s48
    s_and_b32 s17, s49, 0xffff
    s_mov_b32 s18, 0x5100
    s_mov_b32 s19, 0x00020000
    s_add_u32 s20, s10, 0x4c0000
    s_addc_u32 s21, s11, 0
    s_and_b32 s21, s21, 0xffff
    s_mov_b32 s22, 0x26000
    s_mov_b32 s23, 0x00020000
    s_mov_b32 s40, 0
    s_mov_b32 s47, 1
    s_mov_b32 s31, 36
    s_branch g1_bdone
g1_bq:
    s_mul_i32 s36, s29, 384
    s_sub_u32 s37, 663552, s36
    s_add_u32 s16, s4, s36
    s_addc_u32 s17, s5, 0
    s_and_b32 s17, s17, 0xffff
    s_mov_b32 s18, s37
    s_mov_b32 s19, 0x00020000
    s_mov_b32 s31, 1152
    s_add_u32 s36, s36, 2621440
    s_sub_u32 s37, 4980736, s36
    s_add_u32 s20, s10, s36
    s_addc_u32 s21, s11, 0
    s_and_b32 s21, s21, 0xffff
    s_mov_b32 s22, s37
    s_mov_b32 s23, 0x00020000
    s_mov_b32 s40, 1152
    s_branch g1_bdone
g1_bz:
    s_sub_u32 s36, s29, 3
    s_mul_i32 s36, s36, 384
    s_sub_u32 s37, 5308416, s36
    s_add_u32 s16, s6, s36
    s_addc_u32 s17, s7, 0
    s_and_b32 s17, s17, 0xffff
    s_mov_b32 s18, s37
    s_mov_b32 s19, 0x00020000
    s_mov_b32 s31, 9216
    s_add_u32 s36, s36, 5242880
    s_sub_u32 s37, 24117248, s36
    s_add_u32 s20, s10, s36
    s_addc_u32 s21, s11, 0
    s_and_b32 s21, s21, 0xffff
    s_mov_b32 s22, s37
    s_mov_b32 s23, 0x00020000
    s_mov_b32 s40, 9216
g1_bdone:
    v_lshrrev_b32 v1, 6, v0
    s_nop 0
    v_readfirstlane_b32 s30, v1
    v_and_b32 v1, 63, v0
    s_cmp_ge_u32 s30, 8
    s_cbranch_scc1 g1_loader
    v_and_b32 v6, 15, v1
    v_lshrrev_b32 v7, 4, v1

    v_lshrrev_b32 v2, 2, v1
    v_mul_u32_u24 v2, 384, v2
    v_and_b32 v3, 3, v1
    v_lshl_add_u32 v2, v3, 3, v2

    v_bfe_u32 v3, v1, 3, 2
    v_xor_b32 v3, 0, v3
    v_lshl_add_u32 v3, v3, 5, v2
    v_add_u32 v152, 98304, v3
    v_mov_b32 v156, v152
    v_bfe_u32 v3, v1, 3, 2
    v_xor_b32 v3, 1, v3
    v_lshl_add_u32 v3, v3, 5, v2
    v_add_u32 v153, 98304, v3
    v_mov_b32 v157, v153
    v_bfe_u32 v3, v1, 3, 2
    v_xor_b32 v3, 2, v3
    v_lshl_add_u32 v3, v3, 5, v2
    v_add_u32 v154, 98304, v3
    v_mov_b32 v158, v154
    v_bfe_u32 v3, v1, 3, 2
    v_xor_b32 v3, 3, v3
    v_lshl_add_u32 v3, v3, 5, v2
    v_add_u32 v155, 98304, v3
    v_mov_b32 v159, v155
    s_lshl_b32 s36, s30, 12
    v_add_u32 v3, 0, v7
    v_and_b32 v2, 7, v6
    v_xor_b32 v3, v3, v2
    v_lshlrev_b32 v3, 4, v3
    v_lshl_add_u32 v3, v6, 7, v3
    v_add_u32 v160, s36, v3
    v_add_u32 v3, 4, v7
    v_and_b32 v2, 7, v6
    v_xor_b32 v3, v3, v2
    v_lshlrev_b32 v3, 4, v3
    v_lshl_add_u32 v3, v6, 7, v3
    v_add_u32 v161, s36, v3
    s_mul_i32 s36, s28, 256
    s_lshl_b32 s37, s30, 5
    s_add_u32 s36, s36, s37
    v_add_u32 v6, s36, v6

    v_mov_b32 v16, 0
    v_mov_b32 v17, 0
    v_mov_b32 v18, 0
    v_mov_b32 v19, 0
    v_mov_b32 v20, 0
    v_mov_b32 v21, 0
    v_mov_b32 v22, 0
    v_mov_b32 v23, 0
    v_mov_b32 v24, 0
    v_mov_b32 v25, 0
    v_mov_b32 v26, 0
    v_mov_b32 v27, 0
    v_mov_b32 v28, 0
    v_mov_b32 v29, 0
    v_mov_b32 v30, 0
    v_mov_b32 v31, 0
    v_mov_b32 v32, 0
    v_mov_b32 v33, 0
    v_mov_b32 v34, 0
    v_mov_b32 v35, 0
    v_mov_b32 v36, 0
    v_mov_b32 v37, 0
    v_mov_b32 v38, 0
    v_mov_b32 v39, 0
    v_mov_b32 v40, 0
    v_mov_b32 v41, 0
    v_mov_b32 v42, 0
    v_mov_b32 v43, 0
    v_mov_b32 v44, 0
    v_mov_b32 v45, 0
    v_mov_b32 v46, 0
    v_mov_b32 v47, 0
    v_mov_b32 v48, 0
    v_mov_b32 v49, 0
    v_mov_b32 v50, 0
    v_mov_b32 v51, 0
    v_mov_b32 v52, 0
    v_mov_b32 v53, 0
    v_mov_b32 v54, 0
    v_mov_b32 v55, 0
    v_mov_b32 v56, 0
    v_mov_b32 v57, 0
    v_mov_b32 v58, 0
    v_mov_b32 v59, 0
    v_mov_b32 v60, 0
    v_mov_b32 v61, 0
    v_mov_b32 v62, 0
    v_mov_b32 v63, 0
    v_mov_b32 v64, 0
    v_mov_b32 v65, 0
    v_mov_b32 v66, 0
    v_mov_b32 v67, 0
    v_mov_b32 v68, 0
    v_mov_b32 v69, 0
    v_mov_b32 v70, 0
    v_mov_b32 v71, 0
    v_mov_b32 v72, 0
    v_mov_b32 v73, 0
    v_mov_b32 v74, 0
    v_mov_b32 v75, 0
    v_mov_b32 v76, 0
    v_mov_b32 v77, 0
    v_mov_b32 v78, 0
    v_mov_b32 v79, 0
    v_mov_b32 v80, 0
    v_mov_b32 v81, 0
    v_mov_b32 v82, 0
    v_mov_b32 v83, 0
    v_mov_b32 v84, 0
    v_mov_b32 v85, 0
    v_mov_b32 v86, 0
    v_mov_b32 v87, 0
    v_mov_b32 v88, 0
    v_mov_b32 v89, 0
    v_mov_b32 v90, 0
    v_mov_b32 v91, 0
    v_mov_b32 v92, 0
    v_mov_b32 v93, 0
    v_mov_b32 v94, 0
    v_mov_b32 v95, 0
    v_mov_b32 v96, 0
    v_mov_b32 v97, 0
    v_mov_b32 v98, 0
    v_mov_b32 v99, 0
    v_mov_b32 v100, 0
    v_mov_b32 v101, 0
    v_mov_b32 v102, 0
    v_mov_b32 v103, 0
    v_mov_b32 v104, 0
    v_mov_b32 v105, 0
    v_mov_b32 v106, 0
    v_mov_b32 v107, 0
    v_mov_b32 v108, 0
    v_mov_b32 v109, 0
    v_mov_b32 v110, 0
    v_mov_b32 v111, 0
    s_mov_b32 s32, 0
    s_mov_b32 s33, 0
    s_mov_b32 s34, 0
    s_mov_b32 s35, 0
    s_mov_b32 s39, 9
    s_barrier
    ds_read_b128 v[112:115], v160 offset:0
    ds_read_b128 v[116:119], v160 offset:2048
    ds_read_b64_tr_b16 v[128:129], v152 offset:0
    ds_read_b64_tr_b16 v[130:131], v152 offset:6144
    ds_read_b64_tr_b16 v[132:133], v153 offset:0
    ds_read_b64_tr_b16 v[134:135], v153 offset:6144
    ds_read_b64_tr_b16 v[136:137], v154 offset:0
    ds_read_b64_tr_b16 v[138:139], v154 offset:6144
    ds_read_b64_tr_b16 v[140:141], v155 offset:0
    ds_read_b64_tr_b16 v[142:143], v155 offset:6144
g1_loop:
    s_waitcnt lgkmcnt(8)
    s_waitcnt lgkmcnt(6)
    v_mfma_f32_16x16x32_bf16 v[16:19], v[128:131], v[112:115], v[16:19]
    ds_read_b64_tr_b16 v[144:145], v152 offset:128
    ds_read_b64_tr_b16 v[146:147], v152 offset:6272
    v_mfma_f32_16x16x32_bf16 v[64:67], v[128:131], v[116:119], v[64:67]
    s_waitcnt lgkmcnt(6)
    v_mfma_f32_16x16x32_bf16 v[20:23], v[132:135], v[112:115], v[20:23]
    ds_read_b64_tr_b16 v[148:149], v153 offset:128
    ds_read_b64_tr_b16 v[150:151], v153 offset:6272
    v_mfma_f32_16x16x32_bf16 v[68:71], v[132:135], v[116:119], v[68:71]
    s_waitcnt lgkmcnt(6)
    v_mfma_f32_16x16x32_bf16 v[24:27], v[136:139], v[112:115], v[24:27]
    ds_read_b64_tr_b16 v[128:129], v154 offset:128
    ds_read_b64_tr_b16 v[130:131], v154 offset:6272
    v_mfma_f32_16x16x32_bf16 v[72:75], v[136:139], v[116:119], v[72:75]
    s_waitcnt lgkmcnt(6)
    v_mfma_f32_16x16x32_bf16 v[28:31], v[140:143], v[112:115], v[28:31]
    ds_read_b64_tr_b16 v[132:133], v155 offset:128
    ds_read_b64_tr_b16 v[134:135], v155 offset:6272
    v_mfma_f32_16x16x32_bf16 v[76:79], v[140:143], v[116:119], v[76:79]
    s_waitcnt lgkmcnt(6)
    v_mfma_f32_16x16x32_bf16 v[32:35], v[144:147], v[112:115], v[32:35]
    ds_read_b64_tr_b16 v[136:137], v152 offset:256
    ds_read_b64_tr_b16 v[138:139], v152 offset:6400
    v_mfma_f32_16x16x32_bf16 v[80:83], v[144:147], v[116:119], v[80:83]
    s_waitcnt lgkmcnt(6)
    v_mfma_f32_16x16x32_bf16 v[36:39], v[148:151], v[112:115], v[36:39]
    ds_read_b64_tr_b16 v[140:141], v153 offset:256
    ds_read_b64_tr_b16 v[142:143], v153 offset:6400
    v_mfma_f32_16x16x32_bf16 v[84:87], v[148:151], v[116:119], v[84:87]
    s_waitcnt lgkmcnt(6)
    v_mfma_f32_16x16x32_bf16 v[40:43], v[128:131], v[112:115], v[40:43]
    ds_read_b64_tr_b16 v[144:145], v154 offset:256
    ds_read_b64_tr_b16 v[146:147], v154 offset:6400
    v_mfma_f32_16x16x32_bf16 v[88:91], v[128:131], v[116:119], v[88:91]
    s_waitcnt lgkmcnt(6)
    v_mfma_f32_16x16x32_bf16 v[44:47], v[132:135], v[112:115], v[44:47]
    ds_read_b64_tr_b16 v[148:149], v155 offset:256
    ds_read_b64_tr_b16 v[150:151], v155 offset:6400
    v_mfma_f32_16x16x32_bf16 v[92:95], v[132:135], v[116:119], v[92:95]
    s_add_u32 s34, s34, 12288
    s_cmp_eq_u32 s34, 61440
    s_cselect_b32 s34, 0, s34
    s_sub_u32 s36, s34, s33
    s_mov_b32 s33, s34
    v_add_u32 v156, s36, v156
    v_add_u32 v157, s36, v157
    v_add_u32 v158, s36, v158
    v_add_u32 v159, s36, v159
    s_barrier
    ds_read_b128 v[120:123], v161 offset:0
    ds_read_b128 v[124:127], v161 offset:2048
    s_waitcnt lgkmcnt(8)
    v_mfma_f32_16x16x32_bf16 v[48:51], v[136:139], v[112:115], v[48:51]
    ds_read_b64_tr_b16 v[128:129], v156 offset:0
    ds_read_b64_tr_b16 v[130:131], v156 offset:6144
    v_mfma_f32_16x16x32_bf16 v[96:99], v[136:139], v[116:119], v[96:99]
    s_waitcnt lgkmcnt(8)
    v_mfma_f32_16x16x32_bf16 v[52:55], v[140:143], v[112:115], v[52:55]
    ds_read_b64_tr_b16 v[132:133], v157 offset:0
    ds_read_b64_tr_b16 v[134:135], v157 offset:6144
    v_mfma_f32_16x16x32_bf16 v[100:103], v[140:143], v[116:119], v[100:103]
    s_waitcnt lgkmcnt(8)
    v_mfma_f32_16x16x32_bf16 v[56:59], v[144:147], v[112:115], v[56:59]
    ds_read_b64_tr_b16 v[136:137], v158 offset:0
    ds_read_b64_tr_b16 v[138:139], v158 offset:6144
    v_mfma_f32_16x16x32_bf16 v[104:107], v[144:147], v[116:119], v[104:107]
    s_waitcnt lgkmcnt(8)
    v_mfma_f32_16x16x32_bf16 v[60:63], v[148:151], v[112:115], v[60:63]
    ds_read_b64_tr_b16 v[140:141], v159 offset:0
    ds_read_b64_tr_b16 v[142:143], v159 offset:6144
    v_mfma_f32_16x16x32_bf16 v[108:111], v[148:151], v[116:119], v[108:111]
    s_waitcnt lgkmcnt(8)
    s_waitcnt lgkmcnt(6)
    v_mfma_f32_16x16x32_bf16 v[16:19], v[128:131], v[120:123], v[16:19]
    ds_read_b64_tr_b16 v[144:145], v156 offset:128
    ds_read_b64_tr_b16 v[146:147], v156 offset:6272
    v_mfma_f32_16x16x32_bf16 v[64:67], v[128:131], v[124:127], v[64:67]
    s_waitcnt lgkmcnt(6)
    v_mfma_f32_16x16x32_bf16 v[20:23], v[132:135], v[120:123], v[20:23]
    ds_read_b64_tr_b16 v[148:149], v157 offset:128
    ds_read_b64_tr_b16 v[150:151], v157 offset:6272
    v_mfma_f32_16x16x32_bf16 v[68:71], v[132:135], v[124:127], v[68:71]
    s_waitcnt lgkmcnt(6)
    v_mfma_f32_16x16x32_bf16 v[24:27], v[136:139], v[120:123], v[24:27]
    ds_read_b64_tr_b16 v[128:129], v158 offset:128
    ds_read_b64_tr_b16 v[130:131], v158 offset:6272
    v_mfma_f32_16x16x32_bf16 v[72:75], v[136:139], v[124:127], v[72:75]
    s_waitcnt lgkmcnt(6)
    v_mfma_f32_16x16x32_bf16 v[28:31], v[140:143], v[120:123], v[28:31]
    ds_read_b64_tr_b16 v[132:133], v159 offset:128
    ds_read_b64_tr_b16 v[134:135], v159 offset:6272
    v_mfma_f32_16x16x32_bf16 v[76:79], v[140:143], v[124:127], v[76:79]
    s_waitcnt lgkmcnt(6)
    v_mfma_f32_16x16x32_bf16 v[32:35], v[144:147], v[120:123], v[32:35]
    ds_read_b64_tr_b16 v[136:137], v156 offset:256
    ds_read_b64_tr_b16 v[138:139], v156 offset:6400
    v_mfma_f32_16x16x32_bf16 v[80:83], v[144:147], v[124:127], v[80:83]
    s_waitcnt lgkmcnt(6)
    v_mfma_f32_16x16x32_bf16 v[36:39], v[148:151], v[120:123], v[36:39]
    ds_read_b64_tr_b16 v[140:141], v157 offset:256
    ds_read_b64_tr_b16 v[142:143], v157 offset:6400
    v_mfma_f32_16x16x32_bf16 v[84:87], v[148:151], v[124:127], v[84:87]
    s_waitcnt lgkmcnt(6)
    v_mfma_f32_16x16x32_bf16 v[40:43], v[128:131], v[120:123], v[40:43]
    ds_read_b64_tr_b16 v[144:145], v158 offset:256
    ds_read_b64_tr_b16 v[146:147], v158 offset:6400
    v_mfma_f32_16x16x32_bf16 v[88:91], v[128:131], v[124:127], v[88:91]
    s_waitcnt lgkmcnt(6)
    v_mfma_f32_16x16x32_bf16 v[44:47], v[132:135], v[120:123], v[44:47]
    ds_read_b64_tr_b16 v[148:149], v159 offset:256
    ds_read_b64_tr_b16 v[150:151], v159 offset:6400
    v_mfma_f32_16x16x32_bf16 v[92:95], v[132:135], v[124:127], v[92:95]
    s_add_u32 s34, s34, 12288
    s_cmp_eq_u32 s34, 61440
    s_cselect_b32 s34, 0, s34
    s_sub_u32 s36, s34, s32
    s_mov_b32 s32, s34
    v_add_u32 v152, s36, v152
    v_add_u32 v153, s36, v153
    v_add_u32 v154, s36, v154
    v_add_u32 v155, s36, v155
    s_add_u32 s37, s35, 32768
    s_cmp_eq_u32 s37, 98304
    s_cselect_b32 s37, 0, s37
    s_sub_u32 s36, s37, s35
    s_mov_b32 s35, s37
    v_add_u32 v160, s36, v160
    s_mov_b32 s38, s36
    s_barrier
    ds_read_b128 v[112:115], v160 offset:0
    ds_read_b128 v[116:119], v160 offset:2048
    v_add_u32 v161, s38, v161
    s_waitcnt lgkmcnt(8)
    v_mfma_f32_16x16x32_bf16 v[48:51], v[136:139], v[120:123], v[48:51]
    ds_read_b64_tr_b16 v[128:129], v152 offset:0
    ds_read_b64_tr_b16 v[130:131], v152 offset:6144
    v_mfma_f32_16x16x32_bf16 v[96:99], v[136:139], v[124:127], v[96:99]
    s_waitcnt lgkmcnt(8)
    v_mfma_f32_16x16x32_bf16 v[52:55], v[140:143], v[120:123], v[52:55]
    ds_read_b64_tr_b16 v[132:133], v153 offset:0
    ds_read_b64_tr_b16 v[134:135], v153 offset:6144
    v_mfma_f32_16x16x32_bf16 v[100:103], v[140:143], v[124:127], v[100:103]
    s_waitcnt lgkmcnt(8)
    v_mfma_f32_16x16x32_bf16 v[56:59], v[144:147], v[120:123], v[56:59]
    ds_read_b64_tr_b16 v[136:137], v154 offset:0
    ds_read_b64_tr_b16 v[138:139], v154 offset:6144
    v_mfma_f32_16x16x32_bf16 v[104:107], v[144:147], v[124:127], v[104:107]
    s_waitcnt lgkmcnt(8)
    v_mfma_f32_16x16x32_bf16 v[60:63], v[148:151], v[120:123], v[60:63]
    ds_read_b64_tr_b16 v[140:141], v155 offset:0
    ds_read_b64_tr_b16 v[142:143], v155 offset:6144
    v_mfma_f32_16x16x32_bf16 v[108:111], v[148:151], v[124:127], v[108:111]
    s_sub_u32 s39, s39, 1
    s_cmp_lg_u32 s39, 0
    s_cbranch_scc1 g1_loop
    s_waitcnt lgkmcnt(0)
    s_nop 7
    s_nop 7
    s_barrier
    v_mov_b32 v10, v6
    v_mov_b32 v11, v7
    s_cmp_ge_u32 s29, 27
    s_cbranch_scc1 g1_ekv
    s_mul_i32 s44, s30, 12800
    v_and_b32 v2, 15, v1
    v_mul_u32_u24 v2, 400, v2
    v_lshl_add_u32 v2, v11, 3, v2
    v_add_u32 v2, s44, v2
    s_cmp_lt_u32 s29, 3
    s_cbranch_scc1 g1_eq
    s_mov_b32 s36, 0xbdd2d3e8
    s_mov_b32 s37, 0xc0135761
    v_mov_b32 v12, s37
    v_mov_b32 v13, s37
    v_mov_b32 v14, s36
    v_mov_b32 v15, s36

    v_pk_mul_f32 v[112:113], v[16:17], v[16:17]
    v_pk_mul_f32 v[114:115], v[18:19], v[18:19]
    v_pk_fma_f32 v[112:113], v[112:113], v[14:15], v[12:13]
    v_pk_fma_f32 v[114:115], v[114:115], v[14:15], v[12:13]
    v_pk_mul_f32 v[112:113], v[112:113], v[16:17]
    v_pk_mul_f32 v[114:115], v[114:115], v[18:19]
    v_exp_f32 v112, v112
    v_exp_f32 v113, v113
    v_exp_f32 v114, v114
    v_exp_f32 v115, v115
    v_add_f32 v112, 1.0, v112
    v_add_f32 v113, 1.0, v113
    v_add_f32 v114, 1.0, v114
    v_add_f32 v115, 1.0, v115
    v_rcp_f32 v112, v112
    v_rcp_f32 v113, v113
    v_rcp_f32 v114, v114
    v_rcp_f32 v115, v115
    s_nop 0
    v_pk_mul_f32 v[112:113], v[112:113], v[16:17]
    v_pk_mul_f32 v[114:115], v[114:115], v[18:19]
    v_cvt_pk_bf16_f32 v116, v112, v113
    v_cvt_pk_bf16_f32 v117, v114, v115
    ds_write_b64 v2, v[116:117] offset:0
    v_pk_mul_f32 v[120:121], v[20:21], v[20:21]
    v_pk_mul_f32 v[122:123], v[22:23], v[22:23]
    v_pk_fma_f32 v[120:121], v[120:121], v[14:15], v[12:13]
    v_pk_fma_f32 v[122:123], v[122:123], v[14:15], v[12:13]
    v_pk_mul_f32 v[120:121], v[120:121], v[20:21]
    v_pk_mul_f32 v[122:123], v[122:123], v[22:23]
    v_exp_f32 v120, v120
    v_exp_f32 v121, v121
    v_exp_f32 v122, v122
    v_exp_f32 v123, v123
    v_add_f32 v120, 1.0, v120
    v_add_f32 v121, 1.0, v121
    v_add_f32 v122, 1.0, v122
    v_add_f32 v123, 1.0, v123
    v_rcp_f32 v120, v120
    v_rcp_f32 v121, v121
    v_rcp_f32 v122, v122
    v_rcp_f32 v123, v123
    s_nop 0
    v_pk_mul_f32 v[120:121], v[120:121], v[20:21]
    v_pk_mul_f32 v[122:123], v[122:123], v[22:23]
    v_cvt_pk_bf16_f32 v124, v120, v121
    v_cvt_pk_bf16_f32 v125, v122, v123
    ds_write_b64 v2, v[124:125] offset:32
    v_pk_mul_f32 v[128:129], v[24:25], v[24:25]
    v_pk_mul_f32 v[130:131], v[26:27], v[26:27]
    v_pk_fma_f32 v[128:129], v[128:129], v[14:15], v[12:13]
    v_pk_fma_f32 v[130:131], v[130:131], v[14:15], v[12:13]
    v_pk_mul_f32 v[128:129], v[128:129], v[24:25]
    v_pk_mul_f32 v[130:131], v[130:131], v[26:27]
    v_exp_f32 v128, v128
    v_exp_f32 v129, v129
    v_exp_f32 v130, v130
    v_exp_f32 v131, v131
    v_add_f32 v128, 1.0, v128
    v_add_f32 v129, 1.0, v129
    v_add_f32 v130, 1.0, v130
    v_add_f32 v131, 1.0, v131
    v_rcp_f32 v128, v128
    v_rcp_f32 v129, v129
    v_rcp_f32 v130, v130
    v_rcp_f32 v131, v131
    s_nop 0
    v_pk_mul_f32 v[128:129], v[128:129], v[24:25]
    v_pk_mul_f32 v[130:131], v[130:131], v[26:27]
    v_cvt_pk_bf16_f32 v132, v128, v129
    v_cvt_pk_bf16_f32 v133, v130, v131
    ds_write_b64 v2, v[132:133] offset:64
    v_pk_mul_f32 v[136:137], v[28:29], v[28:29]
    v_pk_mul_f32 v[138:139], v[30:31], v[30:31]
    v_pk_fma_f32 v[136:137], v[136:137], v[14:15], v[12:13]
    v_pk_fma_f32 v[138:139], v[138:139], v[14:15], v[12:13]
    v_pk_mul_f32 v[136:137], v[136:137], v[28:29]
    v_pk_mul_f32 v[138:139], v[138:139], v[30:31]
    v_exp_f32 v136, v136
    v_exp_f32 v137, v137
    v_exp_f32 v138, v138
    v_exp_f32 v139, v139
    v_add_f32 v136, 1.0, v136
    v_add_f32 v137, 1.0, v137
    v_add_f32 v138, 1.0, v138
    v_add_f32 v139, 1.0, v139
    v_rcp_f32 v136, v136
    v_rcp_f32 v137, v137
    v_rcp_f32 v138, v138
    v_rcp_f32 v139, v139
    s_nop 0
    v_pk_mul_f32 v[136:137], v[136:137], v[28:29]
    v_pk_mul_f32 v[138:139], v[138:139], v[30:31]
    v_cvt_pk_bf16_f32 v140, v136, v137
    v_cvt_pk_bf16_f32 v141, v138, v139
    ds_write_b64 v2, v[140:141] offset:96
    v_pk_mul_f32 v[112:113], v[32:33], v[32:33]
    v_pk_mul_f32 v[114:115], v[34:35], v[34:35]
    v_pk_fma_f32 v[112:113], v[112:113], v[14:15], v[12:13]
    v_pk_fma_f32 v[114:115], v[114:115], v[14:15], v[12:13]
    v_pk_mul_f32 v[112:113], v[112:113], v[32:33]
    v_pk_mul_f32 v[114:115], v[114:115], v[34:35]
    v_exp_f32 v112, v112
    v_exp_f32 v113, v113
    v_exp_f32 v114, v114
    v_exp_f32 v115, v115
    v_add_f32 v112, 1.0, v112
    v_add_f32 v113, 1.0, v113
    v_add_f32 v114, 1.0, v114
    v_add_f32 v115, 1.0, v115
    v_rcp_f32 v112, v112
    v_rcp_f32 v113, v113
    v_rcp_f32 v114, v114
    v_rcp_f32 v115, v115
    s_nop 0
    v_pk_mul_f32 v[112:113], v[112:113], v[32:33]
    v_pk_mul_f32 v[114:115], v[114:115], v[34:35]
    v_cvt_pk_bf16_f32 v116, v112, v113
    v_cvt_pk_bf16_f32 v117, v114, v115
    ds_write_b64 v2, v[116:117] offset:128
    v_pk_mul_f32 v[120:121], v[36:37], v[36:37]
    v_pk_mul_f32 v[122:123], v[38:39], v[38:39]
    v_pk_fma_f32 v[120:121], v[120:121], v[14:15], v[12:13]
    v_pk_fma_f32 v[122:123], v[122:123], v[14:15], v[12:13]
    v_pk_mul_f32 v[120:121], v[120:121], v[36:37]
    v_pk_mul_f32 v[122:123], v[122:123], v[38:39]
    v_exp_f32 v120, v120
    v_exp_f32 v121, v121
    v_exp_f32 v122, v122
    v_exp_f32 v123, v123
    v_add_f32 v120, 1.0, v120
    v_add_f32 v121, 1.0, v121
    v_add_f32 v122, 1.0, v122
    v_add_f32 v123, 1.0, v123
    v_rcp_f32 v120, v120
    v_rcp_f32 v121, v121
    v_rcp_f32 v122, v122
    v_rcp_f32 v123, v123
    s_nop 0
    v_pk_mul_f32 v[120:121], v[120:121], v[36:37]
    v_pk_mul_f32 v[122:123], v[122:123], v[38:39]
    v_cvt_pk_bf16_f32 v124, v120, v121
    v_cvt_pk_bf16_f32 v125, v122, v123
    ds_write_b64 v2, v[124:125] offset:160
    v_pk_mul_f32 v[128:129], v[40:41], v[40:41]
    v_pk_mul_f32 v[130:131], v[42:43], v[42:43]
    v_pk_fma_f32 v[128:129], v[128:129], v[14:15], v[12:13]
    v_pk_fma_f32 v[130:131], v[130:131], v[14:15], v[12:13]
    v_pk_mul_f32 v[128:129], v[128:129], v[40:41]
    v_pk_mul_f32 v[130:131], v[130:131], v[42:43]
    v_exp_f32 v128, v128
    v_exp_f32 v129, v129
    v_exp_f32 v130, v130
    v_exp_f32 v131, v131
    v_add_f32 v128, 1.0, v128
    v_add_f32 v129, 1.0, v129
    v_add_f32 v130, 1.0, v130
    v_add_f32 v131, 1.0, v131
    v_rcp_f32 v128, v128
    v_rcp_f32 v129, v129
    v_rcp_f32 v130, v130
    v_rcp_f32 v131, v131
    s_nop 0
    v_pk_mul_f32 v[128:129], v[128:129], v[40:41]
    v_pk_mul_f32 v[130:131], v[130:131], v[42:43]
    v_cvt_pk_bf16_f32 v132, v128, v129
    v_cvt_pk_bf16_f32 v133, v130, v131
    ds_write_b64 v2, v[132:133] offset:192
    v_pk_mul_f32 v[136:137], v[44:45], v[44:45]
    v_pk_mul_f32 v[138:139], v[46:47], v[46:47]
    v_pk_fma_f32 v[136:137], v[136:137], v[14:15], v[12:13]
    v_pk_fma_f32 v[138:139], v[138:139], v[14:15], v[12:13]
    v_pk_mul_f32 v[136:137], v[136:137], v[44:45]
    v_pk_mul_f32 v[138:139], v[138:139], v[46:47]
    v_exp_f32 v136, v136
    v_exp_f32 v137, v137
    v_exp_f32 v138, v138
    v_exp_f32 v139, v139
    v_add_f32 v136, 1.0, v136
    v_add_f32 v137, 1.0, v137
    v_add_f32 v138, 1.0, v138
    v_add_f32 v139, 1.0, v139
    v_rcp_f32 v136, v136
    v_rcp_f32 v137, v137
    v_rcp_f32 v138, v138
    v_rcp_f32 v139, v139
    s_nop 0
    v_pk_mul_f32 v[136:137], v[136:137], v[44:45]
    v_pk_mul_f32 v[138:139], v[138:139], v[46:47]
    v_cvt_pk_bf16_f32 v140, v136, v137
    v_cvt_pk_bf16_f32 v141, v138, v139
    ds_write_b64 v2, v[140:141] offset:224
    v_pk_mul_f32 v[112:113], v[48:49], v[48:49]
    v_pk_mul_f32 v[114:115], v[50:51], v[50:51]
    v_pk_fma_f32 v[112:113], v[112:113], v[14:15], v[12:13]
    v_pk_fma_f32 v[114:115], v[114:115], v[14:15], v[12:13]
    v_pk_mul_f32 v[112:113], v[112:113], v[48:49]
    v_pk_mul_f32 v[114:115], v[114:115], v[50:51]
    v_exp_f32 v112, v112
    v_exp_f32 v113, v113
    v_exp_f32 v114, v114
    v_exp_f32 v115, v115
    v_add_f32 v112, 1.0, v112
    v_add_f32 v113, 1.0, v113
    v_add_f32 v114, 1.0, v114
    v_add_f32 v115, 1.0, v115
    v_rcp_f32 v112, v112
    v_rcp_f32 v113, v113
    v_rcp_f32 v114, v114
    v_rcp_f32 v115, v115
    s_nop 0
    v_pk_mul_f32 v[112:113], v[112:113], v[48:49]
    v_pk_mul_f32 v[114:115], v[114:115], v[50:51]
    v_cvt_pk_bf16_f32 v116, v112, v113
    v_cvt_pk_bf16_f32 v117, v114, v115
    ds_write_b64 v2, v[116:117] offset:256
    v_pk_mul_f32 v[120:121], v[52:53], v[52:53]
    v_pk_mul_f32 v[122:123], v[54:55], v[54:55]
    v_pk_fma_f32 v[120:121], v[120:121], v[14:15], v[12:13]
    v_pk_fma_f32 v[122:123], v[122:123], v[14:15], v[12:13]
    v_pk_mul_f32 v[120:121], v[120:121], v[52:53]
    v_pk_mul_f32 v[122:123], v[122:123], v[54:55]
    v_exp_f32 v120, v120
    v_exp_f32 v121, v121
    v_exp_f32 v122, v122
    v_exp_f32 v123, v123
    v_add_f32 v120, 1.0, v120
    v_add_f32 v121, 1.0, v121
    v_add_f32 v122, 1.0, v122
    v_add_f32 v123, 1.0, v123
    v_rcp_f32 v120, v120
    v_rcp_f32 v121, v121
    v_rcp_f32 v122, v122
    v_rcp_f32 v123, v123
    s_nop 0
    v_pk_mul_f32 v[120:121], v[120:121], v[52:53]
    v_pk_mul_f32 v[122:123], v[122:123], v[54:55]
    v_cvt_pk_bf16_f32 v124, v120, v121
    v_cvt_pk_bf16_f32 v125, v122, v123
    ds_write_b64 v2, v[124:125] offset:288
    v_pk_mul_f32 v[128:129], v[56:57], v[56:57]
    v_pk_mul_f32 v[130:131], v[58:59], v[58:59]
    v_pk_fma_f32 v[128:129], v[128:129], v[14:15], v[12:13]
    v_pk_fma_f32 v[130:131], v[130:131], v[14:15], v[12:13]
    v_pk_mul_f32 v[128:129], v[128:129], v[56:57]
    v_pk_mul_f32 v[130:131], v[130:131], v[58:59]
    v_exp_f32 v128, v128
    v_exp_f32 v129, v129
    v_exp_f32 v130, v130
    v_exp_f32 v131, v131
    v_add_f32 v128, 1.0, v128
    v_add_f32 v129, 1.0, v129
    v_add_f32 v130, 1.0, v130
    v_add_f32 v131, 1.0, v131
    v_rcp_f32 v128, v128
    v_rcp_f32 v129, v129
    v_rcp_f32 v130, v130
    v_rcp_f32 v131, v131
    s_nop 0
    v_pk_mul_f32 v[128:129], v[128:129], v[56:57]
    v_pk_mul_f32 v[130:131], v[130:131], v[58:59]
    v_cvt_pk_bf16_f32 v132, v128, v129
    v_cvt_pk_bf16_f32 v133, v130, v131
    ds_write_b64 v2, v[132:133] offset:320
    v_pk_mul_f32 v[136:137], v[60:61], v[60:61]
    v_pk_mul_f32 v[138:139], v[62:63], v[62:63]
    v_pk_fma_f32 v[136:137], v[136:137], v[14:15], v[12:13]
    v_pk_fma_f32 v[138:139], v[138:139], v[14:15], v[12:13]
    v_pk_mul_f32 v[136:137], v[136:137], v[60:61]
    v_pk_mul_f32 v[138:139], v[138:139], v[62:63]
    v_exp_f32 v136, v136
    v_exp_f32 v137, v137
    v_exp_f32 v138, v138
    v_exp_f32 v139, v139
    v_add_f32 v136, 1.0, v136
    v_add_f32 v137, 1.0, v137
    v_add_f32 v138, 1.0, v138
    v_add_f32 v139, 1.0, v139
    v_rcp_f32 v136, v136
    v_rcp_f32 v137, v137
    v_rcp_f32 v138, v138
    v_rcp_f32 v139, v139
    s_nop 0
    v_pk_mul_f32 v[136:137], v[136:137], v[60:61]
    v_pk_mul_f32 v[138:139], v[138:139], v[62:63]
    v_cvt_pk_bf16_f32 v140, v136, v137
    v_cvt_pk_bf16_f32 v141, v138, v139
    ds_write_b64 v2, v[140:141] offset:352
    v_pk_mul_f32 v[112:113], v[64:65], v[64:65]
    v_pk_mul_f32 v[114:115], v[66:67], v[66:67]
    v_pk_fma_f32 v[112:113], v[112:113], v[14:15], v[12:13]
    v_pk_fma_f32 v[114:115], v[114:115], v[14:15], v[12:13]
    v_pk_mul_f32 v[112:113], v[112:113], v[64:65]
    v_pk_mul_f32 v[114:115], v[114:115], v[66:67]
    v_exp_f32 v112, v112
    v_exp_f32 v113, v113
    v_exp_f32 v114, v114
    v_exp_f32 v115, v115
    v_add_f32 v112, 1.0, v112
    v_add_f32 v113, 1.0, v113
    v_add_f32 v114, 1.0, v114
    v_add_f32 v115, 1.0, v115
    v_rcp_f32 v112, v112
    v_rcp_f32 v113, v113
    v_rcp_f32 v114, v114
    v_rcp_f32 v115, v115
    s_nop 0
    v_pk_mul_f32 v[112:113], v[112:113], v[64:65]
    v_pk_mul_f32 v[114:115], v[114:115], v[66:67]
    v_cvt_pk_bf16_f32 v116, v112, v113
    v_cvt_pk_bf16_f32 v117, v114, v115
    ds_write_b64 v2, v[116:117] offset:6400
    v_pk_mul_f32 v[120:121], v[68:69], v[68:69]
    v_pk_mul_f32 v[122:123], v[70:71], v[70:71]
    v_pk_fma_f32 v[120:121], v[120:121], v[14:15], v[12:13]
    v_pk_fma_f32 v[122:123], v[122:123], v[14:15], v[12:13]
    v_pk_mul_f32 v[120:121], v[120:121], v[68:69]
    v_pk_mul_f32 v[122:123], v[122:123], v[70:71]
    v_exp_f32 v120, v120
    v_exp_f32 v121, v121
    v_exp_f32 v122, v122
    v_exp_f32 v123, v123
    v_add_f32 v120, 1.0, v120
    v_add_f32 v121, 1.0, v121
    v_add_f32 v122, 1.0, v122
    v_add_f32 v123, 1.0, v123
    v_rcp_f32 v120, v120
    v_rcp_f32 v121, v121
    v_rcp_f32 v122, v122
    v_rcp_f32 v123, v123
    s_nop 0
    v_pk_mul_f32 v[120:121], v[120:121], v[68:69]
    v_pk_mul_f32 v[122:123], v[122:123], v[70:71]
    v_cvt_pk_bf16_f32 v124, v120, v121
    v_cvt_pk_bf16_f32 v125, v122, v123
    ds_write_b64 v2, v[124:125] offset:6432
    v_pk_mul_f32 v[128:129], v[72:73], v[72:73]
    v_pk_mul_f32 v[130:131], v[74:75], v[74:75]
    v_pk_fma_f32 v[128:129], v[128:129], v[14:15], v[12:13]
    v_pk_fma_f32 v[130:131], v[130:131], v[14:15], v[12:13]
    v_pk_mul_f32 v[128:129], v[128:129], v[72:73]
    v_pk_mul_f32 v[130:131], v[130:131], v[74:75]
    v_exp_f32 v128, v128
    v_exp_f32 v129, v129
    v_exp_f32 v130, v130
    v_exp_f32 v131, v131
    v_add_f32 v128, 1.0, v128
    v_add_f32 v129, 1.0, v129
    v_add_f32 v130, 1.0, v130
    v_add_f32 v131, 1.0, v131
    v_rcp_f32 v128, v128
    v_rcp_f32 v129, v129
    v_rcp_f32 v130, v130
    v_rcp_f32 v131, v131
    s_nop 0
    v_pk_mul_f32 v[128:129], v[128:129], v[72:73]
    v_pk_mul_f32 v[130:131], v[130:131], v[74:75]
    v_cvt_pk_bf16_f32 v132, v128, v129
    v_cvt_pk_bf16_f32 v133, v130, v131
    ds_write_b64 v2, v[132:133] offset:6464
    v_pk_mul_f32 v[136:137], v[76:77], v[76:77]
    v_pk_mul_f32 v[138:139], v[78:79], v[78:79]
    v_pk_fma_f32 v[136:137], v[136:137], v[14:15], v[12:13]
    v_pk_fma_f32 v[138:139], v[138:139], v[14:15], v[12:13]
    v_pk_mul_f32 v[136:137], v[136:137], v[76:77]
    v_pk_mul_f32 v[138:139], v[138:139], v[78:79]
    v_exp_f32 v136, v136
    v_exp_f32 v137, v137
    v_exp_f32 v138, v138
    v_exp_f32 v139, v139
    v_add_f32 v136, 1.0, v136
    v_add_f32 v137, 1.0, v137
    v_add_f32 v138, 1.0, v138
    v_add_f32 v139, 1.0, v139
    v_rcp_f32 v136, v136
    v_rcp_f32 v137, v137
    v_rcp_f32 v138, v138
    v_rcp_f32 v139, v139
    s_nop 0
    v_pk_mul_f32 v[136:137], v[136:137], v[76:77]
    v_pk_mul_f32 v[138:139], v[138:139], v[78:79]
    v_cvt_pk_bf16_f32 v140, v136, v137
    v_cvt_pk_bf16_f32 v141, v138, v139
    ds_write_b64 v2, v[140:141] offset:6496
    v_pk_mul_f32 v[112:113], v[80:81], v[80:81]
    v_pk_mul_f32 v[114:115], v[82:83], v[82:83]
    v_pk_fma_f32 v[112:113], v[112:113], v[14:15], v[12:13]
    v_pk_fma_f32 v[114:115], v[114:115], v[14:15], v[12:13]
    v_pk_mul_f32 v[112:113], v[112:113], v[80:81]
    v_pk_mul_f32 v[114:115], v[114:115], v[82:83]
    v_exp_f32 v112, v112
    v_exp_f32 v113, v113
    v_exp_f32 v114, v114
    v_exp_f32 v115, v115
    v_add_f32 v112, 1.0, v112
    v_add_f32 v113, 1.0, v113
    v_add_f32 v114, 1.0, v114
    v_add_f32 v115, 1.0, v115
    v_rcp_f32 v112, v112
    v_rcp_f32 v113, v113
    v_rcp_f32 v114, v114
    v_rcp_f32 v115, v115
    s_nop 0
    v_pk_mul_f32 v[112:113], v[112:113], v[80:81]
    v_pk_mul_f32 v[114:115], v[114:115], v[82:83]
    v_cvt_pk_bf16_f32 v116, v112, v113
    v_cvt_pk_bf16_f32 v117, v114, v115
    ds_write_b64 v2, v[116:117] offset:6528
    v_pk_mul_f32 v[120:121], v[84:85], v[84:85]
    v_pk_mul_f32 v[122:123], v[86:87], v[86:87]
    v_pk_fma_f32 v[120:121], v[120:121], v[14:15], v[12:13]
    v_pk_fma_f32 v[122:123], v[122:123], v[14:15], v[12:13]
    v_pk_mul_f32 v[120:121], v[120:121], v[84:85]
    v_pk_mul_f32 v[122:123], v[122:123], v[86:87]
    v_exp_f32 v120, v120
    v_exp_f32 v121, v121
    v_exp_f32 v122, v122
    v_exp_f32 v123, v123
    v_add_f32 v120, 1.0, v120
    v_add_f32 v121, 1.0, v121
    v_add_f32 v122, 1.0, v122
    v_add_f32 v123, 1.0, v123
    v_rcp_f32 v120, v120
    v_rcp_f32 v121, v121
    v_rcp_f32 v122, v122
    v_rcp_f32 v123, v123
    s_nop 0
    v_pk_mul_f32 v[120:121], v[120:121], v[84:85]
    v_pk_mul_f32 v[122:123], v[122:123], v[86:87]
    v_cvt_pk_bf16_f32 v124, v120, v121
    v_cvt_pk_bf16_f32 v125, v122, v123
    ds_write_b64 v2, v[124:125] offset:6560
    v_pk_mul_f32 v[128:129], v[88:89], v[88:89]
    v_pk_mul_f32 v[130:131], v[90:91], v[90:91]
    v_pk_fma_f32 v[128:129], v[128:129], v[14:15], v[12:13]
    v_pk_fma_f32 v[130:131], v[130:131], v[14:15], v[12:13]
    v_pk_mul_f32 v[128:129], v[128:129], v[88:89]
    v_pk_mul_f32 v[130:131], v[130:131], v[90:91]
    v_exp_f32 v128, v128
    v_exp_f32 v129, v129
    v_exp_f32 v130, v130
    v_exp_f32 v131, v131
    v_add_f32 v128, 1.0, v128
    v_add_f32 v129, 1.0, v129
    v_add_f32 v130, 1.0, v130
    v_add_f32 v131, 1.0, v131
    v_rcp_f32 v128, v128
    v_rcp_f32 v129, v129
    v_rcp_f32 v130, v130
    v_rcp_f32 v131, v131
    s_nop 0
    v_pk_mul_f32 v[128:129], v[128:129], v[88:89]
    v_pk_mul_f32 v[130:131], v[130:131], v[90:91]
    v_cvt_pk_bf16_f32 v132, v128, v129
    v_cvt_pk_bf16_f32 v133, v130, v131
    ds_write_b64 v2, v[132:133] offset:6592
    v_pk_mul_f32 v[136:137], v[92:93], v[92:93]
    v_pk_mul_f32 v[138:139], v[94:95], v[94:95]
    v_pk_fma_f32 v[136:137], v[136:137], v[14:15], v[12:13]
    v_pk_fma_f32 v[138:139], v[138:139], v[14:15], v[12:13]
    v_pk_mul_f32 v[136:137], v[136:137], v[92:93]
    v_pk_mul_f32 v[138:139], v[138:139], v[94:95]
    v_exp_f32 v136, v136
    v_exp_f32 v137, v137
    v_exp_f32 v138, v138
    v_exp_f32 v139, v139
    v_add_f32 v136, 1.0, v136
    v_add_f32 v137, 1.0, v137
    v_add_f32 v138, 1.0, v138
    v_add_f32 v139, 1.0, v139
    v_rcp_f32 v136, v136
    v_rcp_f32 v137, v137
    v_rcp_f32 v138, v138
    v_rcp_f32 v139, v139
    s_nop 0
    v_pk_mul_f32 v[136:137], v[136:137], v[92:93]
    v_pk_mul_f32 v[138:139], v[138:139], v[94:95]
    v_cvt_pk_bf16_f32 v140, v136, v137
    v_cvt_pk_bf16_f32 v141, v138, v139
    ds_write_b64 v2, v[140:141] offset:6624
    v_pk_mul_f32 v[112:113], v[96:97], v[96:97]
    v_pk_mul_f32 v[114:115], v[98:99], v[98:99]
    v_pk_fma_f32 v[112:113], v[112:113], v[14:15], v[12:13]
    v_pk_fma_f32 v[114:115], v[114:115], v[14:15], v[12:13]
    v_pk_mul_f32 v[112:113], v[112:113], v[96:97]
    v_pk_mul_f32 v[114:115], v[114:115], v[98:99]
    v_exp_f32 v112, v112
    v_exp_f32 v113, v113
    v_exp_f32 v114, v114
    v_exp_f32 v115, v115
    v_add_f32 v112, 1.0, v112
    v_add_f32 v113, 1.0, v113
    v_add_f32 v114, 1.0, v114
    v_add_f32 v115, 1.0, v115
    v_rcp_f32 v112, v112
    v_rcp_f32 v113, v113
    v_rcp_f32 v114, v114
    v_rcp_f32 v115, v115
    s_nop 0
    v_pk_mul_f32 v[112:113], v[112:113], v[96:97]
    v_pk_mul_f32 v[114:115], v[114:115], v[98:99]
    v_cvt_pk_bf16_f32 v116, v112, v113
    v_cvt_pk_bf16_f32 v117, v114, v115
    ds_write_b64 v2, v[116:117] offset:6656
    v_pk_mul_f32 v[120:121], v[100:101], v[100:101]
    v_pk_mul_f32 v[122:123], v[102:103], v[102:103]
    v_pk_fma_f32 v[120:121], v[120:121], v[14:15], v[12:13]
    v_pk_fma_f32 v[122:123], v[122:123], v[14:15], v[12:13]
    v_pk_mul_f32 v[120:121], v[120:121], v[100:101]
    v_pk_mul_f32 v[122:123], v[122:123], v[102:103]
    v_exp_f32 v120, v120
    v_exp_f32 v121, v121
    v_exp_f32 v122, v122
    v_exp_f32 v123, v123
    v_add_f32 v120, 1.0, v120
    v_add_f32 v121, 1.0, v121
    v_add_f32 v122, 1.0, v122
    v_add_f32 v123, 1.0, v123
    v_rcp_f32 v120, v120
    v_rcp_f32 v121, v121
    v_rcp_f32 v122, v122
    v_rcp_f32 v123, v123
    s_nop 0
    v_pk_mul_f32 v[120:121], v[120:121], v[100:101]
    v_pk_mul_f32 v[122:123], v[122:123], v[102:103]
    v_cvt_pk_bf16_f32 v124, v120, v121
    v_cvt_pk_bf16_f32 v125, v122, v123
    ds_write_b64 v2, v[124:125] offset:6688
    v_pk_mul_f32 v[128:129], v[104:105], v[104:105]
    v_pk_mul_f32 v[130:131], v[106:107], v[106:107]
    v_pk_fma_f32 v[128:129], v[128:129], v[14:15], v[12:13]
    v_pk_fma_f32 v[130:131], v[130:131], v[14:15], v[12:13]
    v_pk_mul_f32 v[128:129], v[128:129], v[104:105]
    v_pk_mul_f32 v[130:131], v[130:131], v[106:107]
    v_exp_f32 v128, v128
    v_exp_f32 v129, v129
    v_exp_f32 v130, v130
    v_exp_f32 v131, v131
    v_add_f32 v128, 1.0, v128
    v_add_f32 v129, 1.0, v129
    v_add_f32 v130, 1.0, v130
    v_add_f32 v131, 1.0, v131
    v_rcp_f32 v128, v128
    v_rcp_f32 v129, v129
    v_rcp_f32 v130, v130
    v_rcp_f32 v131, v131
    s_nop 0
    v_pk_mul_f32 v[128:129], v[128:129], v[104:105]
    v_pk_mul_f32 v[130:131], v[130:131], v[106:107]
    v_cvt_pk_bf16_f32 v132, v128, v129
    v_cvt_pk_bf16_f32 v133, v130, v131
    ds_write_b64 v2, v[132:133] offset:6720
    v_pk_mul_f32 v[136:137], v[108:109], v[108:109]
    v_pk_mul_f32 v[138:139], v[110:111], v[110:111]
    v_pk_fma_f32 v[136:137], v[136:137], v[14:15], v[12:13]
    v_pk_fma_f32 v[138:139], v[138:139], v[14:15], v[12:13]
    v_pk_mul_f32 v[136:137], v[136:137], v[108:109]
    v_pk_mul_f32 v[138:139], v[138:139], v[110:111]
    v_exp_f32 v136, v136
    v_exp_f32 v137, v137
    v_exp_f32 v138, v138
    v_exp_f32 v139, v139
    v_add_f32 v136, 1.0, v136
    v_add_f32 v137, 1.0, v137
    v_add_f32 v138, 1.0, v138
    v_add_f32 v139, 1.0, v139
    v_rcp_f32 v136, v136
    v_rcp_f32 v137, v137
    v_rcp_f32 v138, v138
    v_rcp_f32 v139, v139
    s_nop 0
    v_pk_mul_f32 v[136:137], v[136:137], v[108:109]
    v_pk_mul_f32 v[138:139], v[138:139], v[110:111]
    v_cvt_pk_bf16_f32 v140, v136, v137
    v_cvt_pk_bf16_f32 v141, v138, v139
    ds_write_b64 v2, v[140:141] offset:6752
    s_branch g1_st
g1_eq:
    s_mov_b32 s36, 0x3eae1a93
    v_mul_f32 v112, s36, v16
    v_mul_f32 v113, s36, v17
    v_mul_f32 v114, s36, v18
    v_mul_f32 v115, s36, v19
    v_cvt_pk_bf16_f32 v116, v112, v113
    v_cvt_pk_bf16_f32 v117, v114, v115
    ds_write_b64 v2, v[116:117] offset:0
    v_mul_f32 v120, s36, v20
    v_mul_f32 v121, s36, v21
    v_mul_f32 v122, s36, v22
    v_mul_f32 v123, s36, v23
    v_cvt_pk_bf16_f32 v124, v120, v121
    v_cvt_pk_bf16_f32 v125, v122, v123
    ds_write_b64 v2, v[124:125] offset:32
    v_mul_f32 v128, s36, v24
    v_mul_f32 v129, s36, v25
    v_mul_f32 v130, s36, v26
    v_mul_f32 v131, s36, v27
    v_cvt_pk_bf16_f32 v132, v128, v129
    v_cvt_pk_bf16_f32 v133, v130, v131
    ds_write_b64 v2, v[132:133] offset:64
    v_mul_f32 v136, s36, v28
    v_mul_f32 v137, s36, v29
    v_mul_f32 v138, s36, v30
    v_mul_f32 v139, s36, v31
    v_cvt_pk_bf16_f32 v140, v136, v137
    v_cvt_pk_bf16_f32 v141, v138, v139
    ds_write_b64 v2, v[140:141] offset:96
    v_mul_f32 v112, s36, v32
    v_mul_f32 v113, s36, v33
    v_mul_f32 v114, s36, v34
    v_mul_f32 v115, s36, v35
    v_cvt_pk_bf16_f32 v116, v112, v113
    v_cvt_pk_bf16_f32 v117, v114, v115
    ds_write_b64 v2, v[116:117] offset:128
    v_mul_f32 v120, s36, v36
    v_mul_f32 v121, s36, v37
    v_mul_f32 v122, s36, v38
    v_mul_f32 v123, s36, v39
    v_cvt_pk_bf16_f32 v124, v120, v121
    v_cvt_pk_bf16_f32 v125, v122, v123
    ds_write_b64 v2, v[124:125] offset:160
    v_mul_f32 v128, s36, v40
    v_mul_f32 v129, s36, v41
    v_mul_f32 v130, s36, v42
    v_mul_f32 v131, s36, v43
    v_cvt_pk_bf16_f32 v132, v128, v129
    v_cvt_pk_bf16_f32 v133, v130, v131
    ds_write_b64 v2, v[132:133] offset:192
    v_mul_f32 v136, s36, v44
    v_mul_f32 v137, s36, v45
    v_mul_f32 v138, s36, v46
    v_mul_f32 v139, s36, v47
    v_cvt_pk_bf16_f32 v140, v136, v137
    v_cvt_pk_bf16_f32 v141, v138, v139
    ds_write_b64 v2, v[140:141] offset:224
    v_mul_f32 v112, s36, v48
    v_mul_f32 v113, s36, v49
    v_mul_f32 v114, s36, v50
    v_mul_f32 v115, s36, v51
    v_cvt_pk_bf16_f32 v116, v112, v113
    v_cvt_pk_bf16_f32 v117, v114, v115
    ds_write_b64 v2, v[116:117] offset:256
    v_mul_f32 v120, s36, v52
    v_mul_f32 v121, s36, v53
    v_mul_f32 v122, s36, v54
    v_mul_f32 v123, s36, v55
    v_cvt_pk_bf16_f32 v124, v120, v121
    v_cvt_pk_bf16_f32 v125, v122, v123
    ds_write_b64 v2, v[124:125] offset:288
    v_mul_f32 v128, s36, v56
    v_mul_f32 v129, s36, v57
    v_mul_f32 v130, s36, v58
    v_mul_f32 v131, s36, v59
    v_cvt_pk_bf16_f32 v132, v128, v129
    v_cvt_pk_bf16_f32 v133, v130, v131
    ds_write_b64 v2, v[132:133] offset:320
    v_mul_f32 v136, s36, v60
    v_mul_f32 v137, s36, v61
    v_mul_f32 v138, s36, v62
    v_mul_f32 v139, s36, v63
    v_cvt_pk_bf16_f32 v140, v136, v137
    v_cvt_pk_bf16_f32 v141, v138, v139
    ds_write_b64 v2, v[140:141] offset:352
    v_mul_f32 v112, s36, v64
    v_mul_f32 v113, s36, v65
    v_mul_f32 v114, s36, v66
    v_mul_f32 v115, s36, v67
    v_cvt_pk_bf16_f32 v116, v112, v113
    v_cvt_pk_bf16_f32 v117, v114, v115
    ds_write_b64 v2, v[116:117] offset:6400
    v_mul_f32 v120, s36, v68
    v_mul_f32 v121, s36, v69
    v_mul_f32 v122, s36, v70
    v_mul_f32 v123, s36, v71
    v_cvt_pk_bf16_f32 v124, v120, v121
    v_cvt_pk_bf16_f32 v125, v122, v123
    ds_write_b64 v2, v[124:125] offset:6432
    v_mul_f32 v128, s36, v72
    v_mul_f32 v129, s36, v73
    v_mul_f32 v130, s36, v74
    v_mul_f32 v131, s36, v75
    v_cvt_pk_bf16_f32 v132, v128, v129
    v_cvt_pk_bf16_f32 v133, v130, v131
    ds_write_b64 v2, v[132:133] offset:6464
    v_mul_f32 v136, s36, v76
    v_mul_f32 v137, s36, v77
    v_mul_f32 v138, s36, v78
    v_mul_f32 v139, s36, v79
    v_cvt_pk_bf16_f32 v140, v136, v137
    v_cvt_pk_bf16_f32 v141, v138, v139
    ds_write_b64 v2, v[140:141] offset:6496
    v_mul_f32 v112, s36, v80
    v_mul_f32 v113, s36, v81
    v_mul_f32 v114, s36, v82
    v_mul_f32 v115, s36, v83
    v_cvt_pk_bf16_f32 v116, v112, v113
    v_cvt_pk_bf16_f32 v117, v114, v115
    ds_write_b64 v2, v[116:117] offset:6528
    v_mul_f32 v120, s36, v84
    v_mul_f32 v121, s36, v85
    v_mul_f32 v122, s36, v86
    v_mul_f32 v123, s36, v87
    v_cvt_pk_bf16_f32 v124, v120, v121
    v_cvt_pk_bf16_f32 v125, v122, v123
    ds_write_b64 v2, v[124:125] offset:6560
    v_mul_f32 v128, s36, v88
    v_mul_f32 v129, s36, v89
    v_mul_f32 v130, s36, v90
    v_mul_f32 v131, s36, v91
    v_cvt_pk_bf16_f32 v132, v128, v129
    v_cvt_pk_bf16_f32 v133, v130, v131
    ds_write_b64 v2, v[132:133] offset:6592
    v_mul_f32 v136, s36, v92
    v_mul_f32 v137, s36, v93
    v_mul_f32 v138, s36, v94
    v_mul_f32 v139, s36, v95
    v_cvt_pk_bf16_f32 v140, v136, v137
    v_cvt_pk_bf16_f32 v141, v138, v139
    ds_write_b64 v2, v[140:141] offset:6624
    v_mul_f32 v112, s36, v96
    v_mul_f32 v113, s36, v97
    v_mul_f32 v114, s36, v98
    v_mul_f32 v115, s36, v99
    v_cvt_pk_bf16_f32 v116, v112, v113
    v_cvt_pk_bf16_f32 v117, v114, v115
    ds_write_b64 v2, v[116:117] offset:6656
    v_mul_f32 v120, s36, v100
    v_mul_f32 v121, s36, v101
    v_mul_f32 v122, s36, v102
    v_mul_f32 v123, s36, v103
    v_cvt_pk_bf16_f32 v124, v120, v121
    v_cvt_pk_bf16_f32 v125, v122, v123
    ds_write_b64 v2, v[124:125] offset:6688
    v_mul_f32 v128, s36, v104
    v_mul_f32 v129, s36, v105
    v_mul_f32 v130, s36, v106
    v_mul_f32 v131, s36, v107
    v_cvt_pk_bf16_f32 v132, v128, v129
    v_cvt_pk_bf16_f32 v133, v130, v131
    ds_write_b64 v2, v[132:133] offset:6720
    v_mul_f32 v136, s36, v108
    v_mul_f32 v137, s36, v109
    v_mul_f32 v138, s36, v110
    v_mul_f32 v139, s36, v111
    v_cvt_pk_bf16_f32 v140, v136, v137
    v_cvt_pk_bf16_f32 v141, v138, v139
    ds_write_b64 v2, v[140:141] offset:6752
g1_st:
    s_lshl_b32 s36, s28, 8
    s_lshl_b32 s37, s30, 5
    s_add_u32 s36, s36, s37
    s_mul_i32 s36, s36, s40
    v_add_u32 v5, 0, v1
    v_mul_u32_u24 v3, 2731, v5
    v_lshrrev_b32 v3, 16, v3
    v_mul_u32_u24 v4, 24, v3
    v_sub_u32 v4, v5, v4
    v_mul_u32_u24 v5, 400, v3
    v_lshl_add_u32 v5, v4, 4, v5
    v_add_u32 v64, s44, v5
    v_mul_lo_u32 v5, v3, s40
    v_lshl_add_u32 v80, v4, 4, v5
    v_add_u32 v5, 64, v1
    v_mul_u32_u24 v3, 2731, v5
    v_lshrrev_b32 v3, 16, v3
    v_mul_u32_u24 v4, 24, v3
    v_sub_u32 v4, v5, v4
    v_mul_u32_u24 v5, 400, v3
    v_lshl_add_u32 v5, v4, 4, v5
    v_add_u32 v65, s44, v5
    v_mul_lo_u32 v5, v3, s40
    v_lshl_add_u32 v81, v4, 4, v5
    v_add_u32 v5, 128, v1
    v_mul_u32_u24 v3, 2731, v5
    v_lshrrev_b32 v3, 16, v3
    v_mul_u32_u24 v4, 24, v3
    v_sub_u32 v4, v5, v4
    v_mul_u32_u24 v5, 400, v3
    v_lshl_add_u32 v5, v4, 4, v5
    v_add_u32 v66, s44, v5
    v_mul_lo_u32 v5, v3, s40
    v_lshl_add_u32 v82, v4, 4, v5
    v_add_u32 v5, 192, v1
    v_mul_u32_u24 v3, 2731, v5
    v_lshrrev_b32 v3, 16, v3
    v_mul_u32_u24 v4, 24, v3
    v_sub_u32 v4, v5, v4
    v_mul_u32_u24 v5, 400, v3
    v_lshl_add_u32 v5, v4, 4, v5
    v_add_u32 v67, s44, v5
    v_mul_lo_u32 v5, v3, s40
    v_lshl_add_u32 v83, v4, 4, v5
    v_add_u32 v5, 256, v1
    v_mul_u32_u24 v3, 2731, v5
    v_lshrrev_b32 v3, 16, v3
    v_mul_u32_u24 v4, 24, v3
    v_sub_u32 v4, v5, v4
    v_mul_u32_u24 v5, 400, v3
    v_lshl_add_u32 v5, v4, 4, v5
    v_add_u32 v68, s44, v5
    v_mul_lo_u32 v5, v3, s40
    v_lshl_add_u32 v84, v4, 4, v5
    v_add_u32 v5, 320, v1
    v_mul_u32_u24 v3, 2731, v5
    v_lshrrev_b32 v3, 16, v3
    v_mul_u32_u24 v4, 24, v3
    v_sub_u32 v4, v5, v4
    v_mul_u32_u24 v5, 400, v3
    v_lshl_add_u32 v5, v4, 4, v5
    v_add_u32 v69, s44, v5
    v_mul_lo_u32 v5, v3, s40
    v_lshl_add_u32 v85, v4, 4, v5
    v_add_u32 v5, 384, v1
    v_mul_u32_u24 v3, 2731, v5
    v_lshrrev_b32 v3, 16, v3
    v_mul_u32_u24 v4, 24, v3
    v_sub_u32 v4, v5, v4
    v_mul_u32_u24 v5, 400, v3
    v_lshl_add_u32 v5, v4, 4, v5
    v_add_u32 v70, s44, v5
    v_mul_lo_u32 v5, v3, s40
    v_lshl_add_u32 v86, v4, 4, v5
    v_add_u32 v5, 448, v1
    v_mul_u32_u24 v3, 2731, v5
    v_lshrrev_b32 v3, 16, v3
    v_mul_u32_u24 v4, 24, v3
    v_sub_u32 v4, v5, v4
    v_mul_u32_u24 v5, 400, v3
    v_lshl_add_u32 v5, v4, 4, v5
    v_add_u32 v71, s44, v5
    v_mul_lo_u32 v5, v3, s40
    v_lshl_add_u32 v87, v4, 4, v5
    v_add_u32 v5, 512, v1
    v_mul_u32_u24 v3, 2731, v5
    v_lshrrev_b32 v3, 16, v3
    v_mul_u32_u24 v4, 24, v3
    v_sub_u32 v4, v5, v4
    v_mul_u32_u24 v5, 400, v3
    v_lshl_add_u32 v5, v4, 4, v5
    v_add_u32 v72, s44, v5
    v_mul_lo_u32 v5, v3, s40
    v_lshl_add_u32 v88, v4, 4, v5
    v_add_u32 v5, 576, v1
    v_mul_u32_u24 v3, 2731, v5
    v_lshrrev_b32 v3, 16, v3
    v_mul_u32_u24 v4, 24, v3
    v_sub_u32 v4, v5, v4
    v_mul_u32_u24 v5, 400, v3
    v_lshl_add_u32 v5, v4, 4, v5
    v_add_u32 v73, s44, v5
    v_mul_lo_u32 v5, v3, s40
    v_lshl_add_u32 v89, v4, 4, v5
    v_add_u32 v5, 640, v1
    v_mul_u32_u24 v3, 2731, v5
    v_lshrrev_b32 v3, 16, v3
    v_mul_u32_u24 v4, 24, v3
    v_sub_u32 v4, v5, v4
    v_mul_u32_u24 v5, 400, v3
    v_lshl_add_u32 v5, v4, 4, v5
    v_add_u32 v74, s44, v5
    v_mul_lo_u32 v5, v3, s40
    v_lshl_add_u32 v90, v4, 4, v5
    v_add_u32 v5, 704, v1
    v_mul_u32_u24 v3, 2731, v5
    v_lshrrev_b32 v3, 16, v3
    v_mul_u32_u24 v4, 24, v3
    v_sub_u32 v4, v5, v4
    v_mul_u32_u24 v5, 400, v3
    v_lshl_add_u32 v5, v4, 4, v5
    v_add_u32 v75, s44, v5
    v_mul_lo_u32 v5, v3, s40
    v_lshl_add_u32 v91, v4, 4, v5
    s_waitcnt lgkmcnt(0)
    ds_read_b128 v[16:19], v64
    ds_read_b128 v[20:23], v65
    ds_read_b128 v[24:27], v66
    ds_read_b128 v[28:31], v67
    ds_read_b128 v[32:35], v68
    ds_read_b128 v[36:39], v69
    ds_read_b128 v[40:43], v70
    ds_read_b128 v[44:47], v71
    ds_read_b128 v[48:51], v72
    ds_read_b128 v[52:55], v73
    ds_read_b128 v[56:59], v74
    ds_read_b128 v[60:63], v75
    s_waitcnt lgkmcnt(11)
    buffer_store_dwordx4 v[16:19], v80, s[20:23], s36 offen sc0 sc1
    s_waitcnt lgkmcnt(10)
    buffer_store_dwordx4 v[20:23], v81, s[20:23], s36 offen sc0 sc1
    s_waitcnt lgkmcnt(9)
    buffer_store_dwordx4 v[24:27], v82, s[20:23], s36 offen sc0 sc1
    s_waitcnt lgkmcnt(8)
    buffer_store_dwordx4 v[28:31], v83, s[20:23], s36 offen sc0 sc1
    s_waitcnt lgkmcnt(7)
    buffer_store_dwordx4 v[32:35], v84, s[20:23], s36 offen sc0 sc1
    s_waitcnt lgkmcnt(6)
    buffer_store_dwordx4 v[36:39], v85, s[20:23], s36 offen sc0 sc1
    s_waitcnt lgkmcnt(5)
    buffer_store_dwordx4 v[40:43], v86, s[20:23], s36 offen sc0 sc1
    s_waitcnt lgkmcnt(4)
    buffer_store_dwordx4 v[44:47], v87, s[20:23], s36 offen sc0 sc1
    s_waitcnt lgkmcnt(3)
    buffer_store_dwordx4 v[48:51], v88, s[20:23], s36 offen sc0 sc1
    s_waitcnt lgkmcnt(2)
    buffer_store_dwordx4 v[52:55], v89, s[20:23], s36 offen sc0 sc1
    s_waitcnt lgkmcnt(1)
    buffer_store_dwordx4 v[56:59], v90, s[20:23], s36 offen sc0 sc1
    s_waitcnt lgkmcnt(0)
    buffer_store_dwordx4 v[60:63], v91, s[20:23], s36 offen sc0 sc1
    s_endpgm
g1_ekv:
    s_lshl_b32 s36, s28, 3
    s_add_u32 s36, s36, s30
    v_and_b32 v12, 15, v1
    v_lshrrev_b32 v13, 1, v11
    v_lshlrev_b32 v13, 9, v13
    v_lshl_add_u32 v13, v12, 4, v13
    v_and_b32 v14, 1, v11
    v_lshl_add_u32 v13, v14, 3, v13
    s_lshl_b32 s37, s36, 10
    v_add_u32 v13, s37, v13
    v_lshlrev_b32 v14, 2, v10
    v_add_u32 v14, 0x10000, v14
    v_lshrrev_b32 v15, 2, v12
    v_and_b32 v15, 1, v15
    v_mul_u32_u24 v15, 320, v15
    v_lshl_add_u32 v15, v11, 6, v15
    v_and_b32 v2, 3, v12
    v_lshrrev_b32 v3, 3, v12
    v_lshl_add_u32 v2, v3, 2, v2
    v_lshl_add_u32 v15, v2, 1, v15
    s_mul_i32 s37, s36, 1280
    s_add_u32 s37, s37, 73728
    v_add_u32 v15, s37, v15
    v_cmp_eq_u32 s[44:45], 0, v11

    s_cmp_eq_u32 s29, 28
    s_cbranch_scc1 g1_ev
    v_cvt_pk_bf16_f32 v112, v16, v17
    v_cvt_pk_bf16_f32 v113, v18, v19
    buffer_store_dwordx2 v[112:113], v13, s[20:23], 0 offen offset:0
    s_mov_b64 exec, s[44:45]
    v_cvt_pk_bf16_f32 v118, v20, v21
    buffer_store_dword v118, v14, s[20:23], 0 offen offset:0
    s_mov_b64 exec, -1
    v_cvt_pk_bf16_f32 v112, v64, v65
    v_cvt_pk_bf16_f32 v113, v66, v67
    buffer_store_dwordx2 v[112:113], v13, s[20:23], 0 offen offset:256
    s_mov_b64 exec, s[44:45]
    v_cvt_pk_bf16_f32 v118, v68, v69
    buffer_store_dword v118, v14, s[20:23], 0 offen offset:64
    s_mov_b64 exec, -1
    s_endpgm
g1_ev:
    v_cvt_pk_bf16_f32 v114, v16, v16
    buffer_store_short v114, v15, s[20:23], 0 offen offset:0
    v_cvt_pk_bf16_f32 v115, v17, v17
    buffer_store_short v115, v15, s[20:23], 0 offen offset:16
    v_cvt_pk_bf16_f32 v116, v18, v18
    buffer_store_short v116, v15, s[20:23], 0 offen offset:32
    v_cvt_pk_bf16_f32 v117, v19, v19
    buffer_store_short v117, v15, s[20:23], 0 offen offset:48
    s_mov_b64 exec, s[44:45]
    v_cvt_pk_bf16_f32 v119, v20, v20
    v_cvt_pk_bf16_f32 v120, v21, v21
    v_mov_b32 v121, 0x3f80
    v_mov_b32 v122, 0
    buffer_store_short v119, v15, s[20:23], 0 offen offset:256
    buffer_store_short v120, v15, s[20:23], 0 offen offset:272
    buffer_store_short v121, v15, s[20:23], 0 offen offset:288
    buffer_store_short v122, v15, s[20:23], 0 offen offset:304
    s_mov_b64 exec, -1
    v_cvt_pk_bf16_f32 v114, v64, v64
    buffer_store_short v114, v15, s[20:23], 0 offen offset:640
    v_cvt_pk_bf16_f32 v115, v65, v65
    buffer_store_short v115, v15, s[20:23], 0 offen offset:656
    v_cvt_pk_bf16_f32 v116, v66, v66
    buffer_store_short v116, v15, s[20:23], 0 offen offset:672
    v_cvt_pk_bf16_f32 v117, v67, v67
    buffer_store_short v117, v15, s[20:23], 0 offen offset:688
    s_mov_b64 exec, s[44:45]
    v_cvt_pk_bf16_f32 v119, v68, v68
    v_cvt_pk_bf16_f32 v120, v69, v69
    v_mov_b32 v121, 0x3f80
    v_mov_b32 v122, 0
    buffer_store_short v119, v15, s[20:23], 0 offen offset:896
    buffer_store_short v120, v15, s[20:23], 0 offen offset:912
    buffer_store_short v121, v15, s[20:23], 0 offen offset:928
    buffer_store_short v122, v15, s[20:23], 0 offen offset:944
    s_mov_b64 exec, -1
g1_done:
    s_endpgm
g1_loader:
    s_setprio 3
    s_cmp_eq_u32 s30, 9
    s_cbranch_scc1 g1_loaderA
    s_mov_b32 s33, 0
    s_lshl_b32 s35, s31, 5
    v_add_u32 v24, 0, v1
    v_mul_u32_u24 v25, 2731, v24
    v_lshrrev_b32 v25, 16, v25
    v_mul_u32_u24 v26, 24, v25
    v_sub_u32 v26, v24, v26
    v_bfe_u32 v27, v25, 1, 2
    v_lshlrev_b32 v27, 1, v27
    v_xor_b32 v26, v26, v27
    v_bfe_u32 v27, v25, 2, 2
    v_lshlrev_b32 v27, 3, v27
    v_lshrrev_b32 v24, 4, v25
    v_lshl_add_u32 v27, v24, 2, v27
    v_and_b32 v25, 3, v25
    v_add_u32 v25, v25, v27
    v_mul_lo_u32 v25, v25, s31
    v_lshl_add_u32 v4, v26, 4, v25
    v_cmp_gt_u32 vcc, 3, v26
    s_cmp_eq_u32 s47, 1
    s_cselect_b64 vcc, vcc, -1
    v_mov_b32 v27, 0x7fffffff
    v_cndmask_b32 v4, v27, v4, vcc
    s_mov_b32 m0, 98304
    s_nop 0
    buffer_load_dwordx4 v4, s[16:19], s33 offen lds
    v_add_u32 v24, 64, v1
    v_mul_u32_u24 v25, 2731, v24
    v_lshrrev_b32 v25, 16, v25
    v_mul_u32_u24 v26, 24, v25
    v_sub_u32 v26, v24, v26
    v_bfe_u32 v27, v25, 1, 2
    v_lshlrev_b32 v27, 1, v27
    v_xor_b32 v26, v26, v27
    v_bfe_u32 v27, v25, 2, 2
    v_lshlrev_b32 v27, 3, v27
    v_lshrrev_b32 v24, 4, v25
    v_lshl_add_u32 v27, v24, 2, v27
    v_and_b32 v25, 3, v25
    v_add_u32 v25, v25, v27
    v_mul_lo_u32 v25, v25, s31
    v_lshl_add_u32 v5, v26, 4, v25
    v_cmp_gt_u32 vcc, 3, v26
    s_cmp_eq_u32 s47, 1
    s_cselect_b64 vcc, vcc, -1
    v_mov_b32 v27, 0x7fffffff
    v_cndmask_b32 v5, v27, v5, vcc
    s_mov_b32 m0, 99328
    s_nop 0
    buffer_load_dwordx4 v5, s[16:19], s33 offen lds
    v_add_u32 v24, 128, v1
    v_mul_u32_u24 v25, 2731, v24
    v_lshrrev_b32 v25, 16, v25
    v_mul_u32_u24 v26, 24, v25
    v_sub_u32 v26, v24, v26
    v_bfe_u32 v27, v25, 1, 2
    v_lshlrev_b32 v27, 1, v27
    v_xor_b32 v26, v26, v27
    v_bfe_u32 v27, v25, 2, 2
    v_lshlrev_b32 v27, 3, v27
    v_lshrrev_b32 v24, 4, v25
    v_lshl_add_u32 v27, v24, 2, v27
    v_and_b32 v25, 3, v25
    v_add_u32 v25, v25, v27
    v_mul_lo_u32 v25, v25, s31
    v_lshl_add_u32 v6, v26, 4, v25
    v_cmp_gt_u32 vcc, 3, v26
    s_cmp_eq_u32 s47, 1
    s_cselect_b64 vcc, vcc, -1
    v_mov_b32 v27, 0x7fffffff
    v_cndmask_b32 v6, v27, v6, vcc
    s_mov_b32 m0, 100352
    s_nop 0
    buffer_load_dwordx4 v6, s[16:19], s33 offen lds
    v_add_u32 v24, 192, v1
    v_mul_u32_u24 v25, 2731, v24
    v_lshrrev_b32 v25, 16, v25
    v_mul_u32_u24 v26, 24, v25
    v_sub_u32 v26, v24, v26
    v_bfe_u32 v27, v25, 1, 2
    v_lshlrev_b32 v27, 1, v27
    v_xor_b32 v26, v26, v27
    v_bfe_u32 v27, v25, 2, 2
    v_lshlrev_b32 v27, 3, v27
    v_lshrrev_b32 v24, 4, v25
    v_lshl_add_u32 v27, v24, 2, v27
    v_and_b32 v25, 3, v25
    v_add_u32 v25, v25, v27
    v_mul_lo_u32 v25, v25, s31
    v_lshl_add_u32 v7, v26, 4, v25
    v_cmp_gt_u32 vcc, 3, v26
    s_cmp_eq_u32 s47, 1
    s_cselect_b64 vcc, vcc, -1
    v_mov_b32 v27, 0x7fffffff
    v_cndmask_b32 v7, v27, v7, vcc
    s_mov_b32 m0, 101376
    s_nop 0
    buffer_load_dwordx4 v7, s[16:19], s33 offen lds
    v_add_u32 v24, 256, v1
    v_mul_u32_u24 v25, 2731, v24
    v_lshrrev_b32 v25, 16, v25
    v_mul_u32_u24 v26, 24, v25
    v_sub_u32 v26, v24, v26
    v_bfe_u32 v27, v25, 1, 2
    v_lshlrev_b32 v27, 1, v27
    v_xor_b32 v26, v26, v27
    v_bfe_u32 v27, v25, 2, 2
    v_lshlrev_b32 v27, 3, v27
    v_lshrrev_b32 v24, 4, v25
    v_lshl_add_u32 v27, v24, 2, v27
    v_and_b32 v25, 3, v25
    v_add_u32 v25, v25, v27
    v_mul_lo_u32 v25, v25, s31
    v_lshl_add_u32 v8, v26, 4, v25
    v_cmp_gt_u32 vcc, 3, v26
    s_cmp_eq_u32 s47, 1
    s_cselect_b64 vcc, vcc, -1
    v_mov_b32 v27, 0x7fffffff
    v_cndmask_b32 v8, v27, v8, vcc
    s_mov_b32 m0, 102400
    s_nop 0
    buffer_load_dwordx4 v8, s[16:19], s33 offen lds
    v_add_u32 v24, 320, v1
    v_mul_u32_u24 v25, 2731, v24
    v_lshrrev_b32 v25, 16, v25
    v_mul_u32_u24 v26, 24, v25
    v_sub_u32 v26, v24, v26
    v_bfe_u32 v27, v25, 1, 2
    v_lshlrev_b32 v27, 1, v27
    v_xor_b32 v26, v26, v27
    v_bfe_u32 v27, v25, 2, 2
    v_lshlrev_b32 v27, 3, v27
    v_lshrrev_b32 v24, 4, v25
    v_lshl_add_u32 v27, v24, 2, v27
    v_and_b32 v25, 3, v25
    v_add_u32 v25, v25, v27
    v_mul_lo_u32 v25, v25, s31
    v_lshl_add_u32 v9, v26, 4, v25
    v_cmp_gt_u32 vcc, 3, v26
    s_cmp_eq_u32 s47, 1
    s_cselect_b64 vcc, vcc, -1
    v_mov_b32 v27, 0x7fffffff
    v_cndmask_b32 v9, v27, v9, vcc
    s_mov_b32 m0, 103424
    s_nop 0
    buffer_load_dwordx4 v9, s[16:19], s33 offen lds
    v_add_u32 v24, 384, v1
    v_mul_u32_u24 v25, 2731, v24
    v_lshrrev_b32 v25, 16, v25
    v_mul_u32_u24 v26, 24, v25
    v_sub_u32 v26, v24, v26
    v_bfe_u32 v27, v25, 1, 2
    v_lshlrev_b32 v27, 1, v27
    v_xor_b32 v26, v26, v27
    v_bfe_u32 v27, v25, 2, 2
    v_lshlrev_b32 v27, 3, v27
    v_lshrrev_b32 v24, 4, v25
    v_lshl_add_u32 v27, v24, 2, v27
    v_and_b32 v25, 3, v25
    v_add_u32 v25, v25, v27
    v_mul_lo_u32 v25, v25, s31
    v_lshl_add_u32 v10, v26, 4, v25
    v_cmp_gt_u32 vcc, 3, v26
    s_cmp_eq_u32 s47, 1
    s_cselect_b64 vcc, vcc, -1
    v_mov_b32 v27, 0x7fffffff
    v_cndmask_b32 v10, v27, v10, vcc
    s_mov_b32 m0, 104448
    s_nop 0
    buffer_load_dwordx4 v10, s[16:19], s33 offen lds
    v_add_u32 v24, 448, v1
    v_mul_u32_u24 v25, 2731, v24
    v_lshrrev_b32 v25, 16, v25
    v_mul_u32_u24 v26, 24, v25
    v_sub_u32 v26, v24, v26
    v_bfe_u32 v27, v25, 1, 2
    v_lshlrev_b32 v27, 1, v27
    v_xor_b32 v26, v26, v27
    v_bfe_u32 v27, v25, 2, 2
    v_lshlrev_b32 v27, 3, v27
    v_lshrrev_b32 v24, 4, v25
    v_lshl_add_u32 v27, v24, 2, v27
    v_and_b32 v25, 3, v25
    v_add_u32 v25, v25, v27
    v_mul_lo_u32 v25, v25, s31
    v_lshl_add_u32 v11, v26, 4, v25
    v_cmp_gt_u32 vcc, 3, v26
    s_cmp_eq_u32 s47, 1
    s_cselect_b64 vcc, vcc, -1
    v_mov_b32 v27, 0x7fffffff
    v_cndmask_b32 v11, v27, v11, vcc
    s_mov_b32 m0, 105472
    s_nop 0
    buffer_load_dwordx4 v11, s[16:19], s33 offen lds
    v_add_u32 v24, 512, v1
    v_mul_u32_u24 v25, 2731, v24
    v_lshrrev_b32 v25, 16, v25
    v_mul_u32_u24 v26, 24, v25
    v_sub_u32 v26, v24, v26
    v_bfe_u32 v27, v25, 1, 2
    v_lshlrev_b32 v27, 1, v27
    v_xor_b32 v26, v26, v27
    v_bfe_u32 v27, v25, 2, 2
    v_lshlrev_b32 v27, 3, v27
    v_lshrrev_b32 v24, 4, v25
    v_lshl_add_u32 v27, v24, 2, v27
    v_and_b32 v25, 3, v25
    v_add_u32 v25, v25, v27
    v_mul_lo_u32 v25, v25, s31
    v_lshl_add_u32 v12, v26, 4, v25
    v_cmp_gt_u32 vcc, 3, v26
    s_cmp_eq_u32 s47, 1
    s_cselect_b64 vcc, vcc, -1
    v_mov_b32 v27, 0x7fffffff
    v_cndmask_b32 v12, v27, v12, vcc
    s_mov_b32 m0, 106496
    s_nop 0
    buffer_load_dwordx4 v12, s[16:19], s33 offen lds
    v_add_u32 v24, 576, v1
    v_mul_u32_u24 v25, 2731, v24
    v_lshrrev_b32 v25, 16, v25
    v_mul_u32_u24 v26, 24, v25
    v_sub_u32 v26, v24, v26
    v_bfe_u32 v27, v25, 1, 2
    v_lshlrev_b32 v27, 1, v27
    v_xor_b32 v26, v26, v27
    v_bfe_u32 v27, v25, 2, 2
    v_lshlrev_b32 v27, 3, v27
    v_lshrrev_b32 v24, 4, v25
    v_lshl_add_u32 v27, v24, 2, v27
    v_and_b32 v25, 3, v25
    v_add_u32 v25, v25, v27
    v_mul_lo_u32 v25, v25, s31
    v_lshl_add_u32 v13, v26, 4, v25
    v_cmp_gt_u32 vcc, 3, v26
    s_cmp_eq_u32 s47, 1
    s_cselect_b64 vcc, vcc, -1
    v_mov_b32 v27, 0x7fffffff
    v_cndmask_b32 v13, v27, v13, vcc
    s_mov_b32 m0, 107520
    s_nop 0
    buffer_load_dwordx4 v13, s[16:19], s33 offen lds
    v_add_u32 v24, 640, v1
    v_mul_u32_u24 v25, 2731, v24
    v_lshrrev_b32 v25, 16, v25
    v_mul_u32_u24 v26, 24, v25
    v_sub_u32 v26, v24, v26
    v_bfe_u32 v27, v25, 1, 2
    v_lshlrev_b32 v27, 1, v27
    v_xor_b32 v26, v26, v27
    v_bfe_u32 v27, v25, 2, 2
    v_lshlrev_b32 v27, 3, v27
    v_lshrrev_b32 v24, 4, v25
    v_lshl_add_u32 v27, v24, 2, v27
    v_and_b32 v25, 3, v25
    v_add_u32 v25, v25, v27
    v_mul_lo_u32 v25, v25, s31
    v_lshl_add_u32 v14, v26, 4, v25
    v_cmp_gt_u32 vcc, 3, v26
    s_cmp_eq_u32 s47, 1
    s_cselect_b64 vcc, vcc, -1
    v_mov_b32 v27, 0x7fffffff
    v_cndmask_b32 v14, v27, v14, vcc
    s_mov_b32 m0, 108544
    s_nop 0
    buffer_load_dwordx4 v14, s[16:19], s33 offen lds
    v_add_u32 v24, 704, v1
    v_mul_u32_u24 v25, 2731, v24
    v_lshrrev_b32 v25, 16, v25
    v_mul_u32_u24 v26, 24, v25
    v_sub_u32 v26, v24, v26
    v_bfe_u32 v27, v25, 1, 2
    v_lshlrev_b32 v27, 1, v27
    v_xor_b32 v26, v26, v27
    v_bfe_u32 v27, v25, 2, 2
    v_lshlrev_b32 v27, 3, v27
    v_lshrrev_b32 v24, 4, v25
    v_lshl_add_u32 v27, v24, 2, v27
    v_and_b32 v25, 3, v25
    v_add_u32 v25, v25, v27
    v_mul_lo_u32 v25, v25, s31
    v_lshl_add_u32 v15, v26, 4, v25
    v_cmp_gt_u32 vcc, 3, v26
    s_cmp_eq_u32 s47, 1
    s_cselect_b64 vcc, vcc, -1
    v_mov_b32 v27, 0x7fffffff
    v_cndmask_b32 v15, v27, v15, vcc
    s_mov_b32 m0, 109568
    s_nop 0
    buffer_load_dwordx4 v15, s[16:19], s33 offen lds
    s_mov_b32 s34, 12288
    s_add_u32 s33, s33, s35
    s_mov_b32 s39, 2
g1_lpre:
    s_add_u32 m0, s34, 98304
    s_nop 0
    buffer_load_dwordx4 v4, s[16:19], s33 offen lds
    s_add_u32 m0, s34, 99328
    s_nop 0
    buffer_load_dwordx4 v5, s[16:19], s33 offen lds
    s_add_u32 m0, s34, 100352
    s_nop 0
    buffer_load_dwordx4 v6, s[16:19], s33 offen lds
    s_add_u32 m0, s34, 101376
    s_nop 0
    buffer_load_dwordx4 v7, s[16:19], s33 offen lds
    s_add_u32 m0, s34, 102400
    s_nop 0
    buffer_load_dwordx4 v8, s[16:19], s33 offen lds
    s_add_u32 m0, s34, 103424
    s_nop 0
    buffer_load_dwordx4 v9, s[16:19], s33 offen lds
    s_add_u32 m0, s34, 104448
    s_nop 0
    buffer_load_dwordx4 v10, s[16:19], s33 offen lds
    s_add_u32 m0, s34, 105472
    s_nop 0
    buffer_load_dwordx4 v11, s[16:19], s33 offen lds
    s_add_u32 m0, s34, 106496
    s_nop 0
    buffer_load_dwordx4 v12, s[16:19], s33 offen lds
    s_add_u32 m0, s34, 107520
    s_nop 0
    buffer_load_dwordx4 v13, s[16:19], s33 offen lds
    s_add_u32 m0, s34, 108544
    s_nop 0
    buffer_load_dwordx4 v14, s[16:19], s33 offen lds
    s_add_u32 m0, s34, 109568
    s_nop 0
    buffer_load_dwordx4 v15, s[16:19], s33 offen lds
    s_add_u32 s33, s33, s35
    s_add_u32 s34, s34, 12288
    s_cmp_eq_u32 s34, 61440
    s_cselect_b32 s34, 0, s34
    s_sub_u32 s39, s39, 1
    s_cmp_lg_u32 s39, 0
    s_cbranch_scc1 g1_lpre
    s_mov_b32 s39, 18
g1_lloopB:
    s_waitcnt vmcnt(24)
    s_barrier
    s_add_u32 m0, s34, 98304
    s_nop 0
    buffer_load_dwordx4 v4, s[16:19], s33 offen lds
    s_add_u32 m0, s34, 99328
    s_nop 0
    buffer_load_dwordx4 v5, s[16:19], s33 offen lds
    s_add_u32 m0, s34, 100352
    s_nop 0
    buffer_load_dwordx4 v6, s[16:19], s33 offen lds
    s_add_u32 m0, s34, 101376
    s_nop 0
    buffer_load_dwordx4 v7, s[16:19], s33 offen lds
    s_add_u32 m0, s34, 102400
    s_nop 0
    buffer_load_dwordx4 v8, s[16:19], s33 offen lds
    s_add_u32 m0, s34, 103424
    s_nop 0
    buffer_load_dwordx4 v9, s[16:19], s33 offen lds
    s_add_u32 m0, s34, 104448
    s_nop 0
    buffer_load_dwordx4 v10, s[16:19], s33 offen lds
    s_add_u32 m0, s34, 105472
    s_nop 0
    buffer_load_dwordx4 v11, s[16:19], s33 offen lds
    s_add_u32 m0, s34, 106496
    s_nop 0
    buffer_load_dwordx4 v12, s[16:19], s33 offen lds
    s_add_u32 m0, s34, 107520
    s_nop 0
    buffer_load_dwordx4 v13, s[16:19], s33 offen lds
    s_add_u32 m0, s34, 108544
    s_nop 0
    buffer_load_dwordx4 v14, s[16:19], s33 offen lds
    s_add_u32 m0, s34, 109568
    s_nop 0
    buffer_load_dwordx4 v15, s[16:19], s33 offen lds
    s_add_u32 s33, s33, s35
    s_add_u32 s34, s34, 12288
    s_cmp_eq_u32 s34, 61440
    s_cselect_b32 s34, 0, s34
    s_sub_u32 s39, s39, 1
    s_cmp_lg_u32 s39, 0
    s_cbranch_scc1 g1_lloopB
    s_waitcnt vmcnt(0)
    s_barrier
    s_endpgm
g1_loaderA:
    v_lshrrev_b32 v3, 3, v1
    v_and_b32 v4, 7, v1
    v_xor_b32 v4, v4, v3
    s_mul_i32 s36, s28, 256
    v_add_u32 v3, s36, v3
    s_mov_b32 s37, 1152
    v_mul_lo_u32 v2, v3, s37
    v_lshl_add_u32 v2, v4, 4, v2
    s_mov_b32 s32, 0
    s_mov_b32 s34, 0

    s_mov_b32 s39, 2
g1_lpreA:
    s_add_u32 s36, s32, 0
    s_add_u32 m0, s34, 0
    s_nop 0
    buffer_load_dwordx4 v2, s[12:15], s36 offen lds
    s_add_u32 s36, s32, 9216
    s_add_u32 m0, s34, 1024
    s_nop 0
    buffer_load_dwordx4 v2, s[12:15], s36 offen lds
    s_add_u32 s36, s32, 18432
    s_add_u32 m0, s34, 2048
    s_nop 0
    buffer_load_dwordx4 v2, s[12:15], s36 offen lds
    s_add_u32 s36, s32, 27648
    s_add_u32 m0, s34, 3072
    s_nop 0
    buffer_load_dwordx4 v2, s[12:15], s36 offen lds
    s_add_u32 s36, s32, 36864
    s_add_u32 m0, s34, 4096
    s_nop 0
    buffer_load_dwordx4 v2, s[12:15], s36 offen lds
    s_add_u32 s36, s32, 46080
    s_add_u32 m0, s34, 5120
    s_nop 0
    buffer_load_dwordx4 v2, s[12:15], s36 offen lds
    s_add_u32 s36, s32, 55296
    s_add_u32 m0, s34, 6144
    s_nop 0
    buffer_load_dwordx4 v2, s[12:15], s36 offen lds
    s_add_u32 s36, s32, 64512
    s_add_u32 m0, s34, 7168
    s_nop 0
    buffer_load_dwordx4 v2, s[12:15], s36 offen lds
    s_add_u32 s36, s32, 73728
    s_add_u32 m0, s34, 8192
    s_nop 0
    buffer_load_dwordx4 v2, s[12:15], s36 offen lds
    s_add_u32 s36, s32, 82944
    s_add_u32 m0, s34, 9216
    s_nop 0
    buffer_load_dwordx4 v2, s[12:15], s36 offen lds
    s_add_u32 s36, s32, 92160
    s_add_u32 m0, s34, 10240
    s_nop 0
    buffer_load_dwordx4 v2, s[12:15], s36 offen lds
    s_add_u32 s36, s32, 101376
    s_add_u32 m0, s34, 11264
    s_nop 0
    buffer_load_dwordx4 v2, s[12:15], s36 offen lds
    s_add_u32 s36, s32, 110592
    s_add_u32 m0, s34, 12288
    s_nop 0
    buffer_load_dwordx4 v2, s[12:15], s36 offen lds
    s_add_u32 s36, s32, 119808
    s_add_u32 m0, s34, 13312
    s_nop 0
    buffer_load_dwordx4 v2, s[12:15], s36 offen lds
    s_add_u32 s36, s32, 129024
    s_add_u32 m0, s34, 14336
    s_nop 0
    buffer_load_dwordx4 v2, s[12:15], s36 offen lds
    s_add_u32 s36, s32, 138240
    s_add_u32 m0, s34, 15360
    s_nop 0
    buffer_load_dwordx4 v2, s[12:15], s36 offen lds
    s_add_u32 s36, s32, 147456
    s_add_u32 m0, s34, 16384
    s_nop 0
    buffer_load_dwordx4 v2, s[12:15], s36 offen lds
    s_add_u32 s36, s32, 156672
    s_add_u32 m0, s34, 17408
    s_nop 0
    buffer_load_dwordx4 v2, s[12:15], s36 offen lds
    s_add_u32 s36, s32, 165888
    s_add_u32 m0, s34, 18432
    s_nop 0
    buffer_load_dwordx4 v2, s[12:15], s36 offen lds
    s_add_u32 s36, s32, 175104
    s_add_u32 m0, s34, 19456
    s_nop 0
    buffer_load_dwordx4 v2, s[12:15], s36 offen lds
    s_add_u32 s36, s32, 184320
    s_add_u32 m0, s34, 20480
    s_nop 0
    buffer_load_dwordx4 v2, s[12:15], s36 offen lds
    s_add_u32 s36, s32, 193536
    s_add_u32 m0, s34, 21504
    s_nop 0
    buffer_load_dwordx4 v2, s[12:15], s36 offen lds
    s_add_u32 s36, s32, 202752
    s_add_u32 m0, s34, 22528
    s_nop 0
    buffer_load_dwordx4 v2, s[12:15], s36 offen lds
    s_add_u32 s36, s32, 211968
    s_add_u32 m0, s34, 23552
    s_nop 0
    buffer_load_dwordx4 v2, s[12:15], s36 offen lds
    s_add_u32 s36, s32, 221184
    s_add_u32 m0, s34, 24576
    s_nop 0
    buffer_load_dwordx4 v2, s[12:15], s36 offen lds
    s_add_u32 s36, s32, 230400
    s_add_u32 m0, s34, 25600
    s_nop 0
    buffer_load_dwordx4 v2, s[12:15], s36 offen lds
    s_add_u32 s36, s32, 239616
    s_add_u32 m0, s34, 26624
    s_nop 0
    buffer_load_dwordx4 v2, s[12:15], s36 offen lds
    s_add_u32 s36, s32, 248832
    s_add_u32 m0, s34, 27648
    s_nop 0
    buffer_load_dwordx4 v2, s[12:15], s36 offen lds
    s_add_u32 s36, s32, 258048
    s_add_u32 m0, s34, 28672
    s_nop 0
    buffer_load_dwordx4 v2, s[12:15], s36 offen lds
    s_add_u32 s36, s32, 267264
    s_add_u32 m0, s34, 29696
    s_nop 0
    buffer_load_dwordx4 v2, s[12:15], s36 offen lds
    s_add_u32 s36, s32, 276480
    s_add_u32 m0, s34, 30720
    s_nop 0
    buffer_load_dwordx4 v2, s[12:15], s36 offen lds
    s_add_u32 s36, s32, 285696
    s_add_u32 m0, s34, 31744
    s_nop 0
    buffer_load_dwordx4 v2, s[12:15], s36 offen lds
    s_add_u32 s32, s32, 128
    s_add_u32 s34, s34, 32768
    s_cmp_eq_u32 s34, 98304
    s_cselect_b32 s34, 0, s34
    s_sub_u32 s39, s39, 1
    s_cmp_lg_u32 s39, 0
    s_cbranch_scc1 g1_lpreA
    s_mov_b32 s39, 9
g1_lloopA:
    s_waitcnt vmcnt(32)
    s_barrier
    s_barrier
    s_add_u32 s36, s32, 0
    s_add_u32 m0, s34, 0
    s_nop 0
    buffer_load_dwordx4 v2, s[12:15], s36 offen lds
    s_add_u32 s36, s32, 9216
    s_add_u32 m0, s34, 1024
    s_nop 0
    buffer_load_dwordx4 v2, s[12:15], s36 offen lds
    s_add_u32 s36, s32, 18432
    s_add_u32 m0, s34, 2048
    s_nop 0
    buffer_load_dwordx4 v2, s[12:15], s36 offen lds
    s_add_u32 s36, s32, 27648
    s_add_u32 m0, s34, 3072
    s_nop 0
    buffer_load_dwordx4 v2, s[12:15], s36 offen lds
    s_add_u32 s36, s32, 36864
    s_add_u32 m0, s34, 4096
    s_nop 0
    buffer_load_dwordx4 v2, s[12:15], s36 offen lds
    s_add_u32 s36, s32, 46080
    s_add_u32 m0, s34, 5120
    s_nop 0
    buffer_load_dwordx4 v2, s[12:15], s36 offen lds
    s_add_u32 s36, s32, 55296
    s_add_u32 m0, s34, 6144
    s_nop 0
    buffer_load_dwordx4 v2, s[12:15], s36 offen lds
    s_add_u32 s36, s32, 64512
    s_add_u32 m0, s34, 7168
    s_nop 0
    buffer_load_dwordx4 v2, s[12:15], s36 offen lds
    s_add_u32 s36, s32, 73728
    s_add_u32 m0, s34, 8192
    s_nop 0
    buffer_load_dwordx4 v2, s[12:15], s36 offen lds
    s_add_u32 s36, s32, 82944
    s_add_u32 m0, s34, 9216
    s_nop 0
    buffer_load_dwordx4 v2, s[12:15], s36 offen lds
    s_add_u32 s36, s32, 92160
    s_add_u32 m0, s34, 10240
    s_nop 0
    buffer_load_dwordx4 v2, s[12:15], s36 offen lds
    s_add_u32 s36, s32, 101376
    s_add_u32 m0, s34, 11264
    s_nop 0
    buffer_load_dwordx4 v2, s[12:15], s36 offen lds
    s_add_u32 s36, s32, 110592
    s_add_u32 m0, s34, 12288
    s_nop 0
    buffer_load_dwordx4 v2, s[12:15], s36 offen lds
    s_add_u32 s36, s32, 119808
    s_add_u32 m0, s34, 13312
    s_nop 0
    buffer_load_dwordx4 v2, s[12:15], s36 offen lds
    s_add_u32 s36, s32, 129024
    s_add_u32 m0, s34, 14336
    s_nop 0
    buffer_load_dwordx4 v2, s[12:15], s36 offen lds
    s_add_u32 s36, s32, 138240
    s_add_u32 m0, s34, 15360
    s_nop 0
    buffer_load_dwordx4 v2, s[12:15], s36 offen lds
    s_add_u32 s36, s32, 147456
    s_add_u32 m0, s34, 16384
    s_nop 0
    buffer_load_dwordx4 v2, s[12:15], s36 offen lds
    s_add_u32 s36, s32, 156672
    s_add_u32 m0, s34, 17408
    s_nop 0
    buffer_load_dwordx4 v2, s[12:15], s36 offen lds
    s_add_u32 s36, s32, 165888
    s_add_u32 m0, s34, 18432
    s_nop 0
    buffer_load_dwordx4 v2, s[12:15], s36 offen lds
    s_add_u32 s36, s32, 175104
    s_add_u32 m0, s34, 19456
    s_nop 0
    buffer_load_dwordx4 v2, s[12:15], s36 offen lds
    s_add_u32 s36, s32, 184320
    s_add_u32 m0, s34, 20480
    s_nop 0
    buffer_load_dwordx4 v2, s[12:15], s36 offen lds
    s_add_u32 s36, s32, 193536
    s_add_u32 m0, s34, 21504
    s_nop 0
    buffer_load_dwordx4 v2, s[12:15], s36 offen lds
    s_add_u32 s36, s32, 202752
    s_add_u32 m0, s34, 22528
    s_nop 0
    buffer_load_dwordx4 v2, s[12:15], s36 offen lds
    s_add_u32 s36, s32, 211968
    s_add_u32 m0, s34, 23552
    s_nop 0
    buffer_load_dwordx4 v2, s[12:15], s36 offen lds
    s_add_u32 s36, s32, 221184
    s_add_u32 m0, s34, 24576
    s_nop 0
    buffer_load_dwordx4 v2, s[12:15], s36 offen lds
    s_add_u32 s36, s32, 230400
    s_add_u32 m0, s34, 25600
    s_nop 0
    buffer_load_dwordx4 v2, s[12:15], s36 offen lds
    s_add_u32 s36, s32, 239616
    s_add_u32 m0, s34, 26624
    s_nop 0
    buffer_load_dwordx4 v2, s[12:15], s36 offen lds
    s_add_u32 s36, s32, 248832
    s_add_u32 m0, s34, 27648
    s_nop 0
    buffer_load_dwordx4 v2, s[12:15], s36 offen lds
    s_add_u32 s36, s32, 258048
    s_add_u32 m0, s34, 28672
    s_nop 0
    buffer_load_dwordx4 v2, s[12:15], s36 offen lds
    s_add_u32 s36, s32, 267264
    s_add_u32 m0, s34, 29696
    s_nop 0
    buffer_load_dwordx4 v2, s[12:15], s36 offen lds
    s_add_u32 s36, s32, 276480
    s_add_u32 m0, s34, 30720
    s_nop 0
    buffer_load_dwordx4 v2, s[12:15], s36 offen lds
    s_add_u32 s36, s32, 285696
    s_add_u32 m0, s34, 31744
    s_nop 0
    buffer_load_dwordx4 v2, s[12:15], s36 offen lds
    s_add_u32 s32, s32, 128
    s_add_u32 s34, s34, 32768
    s_cmp_eq_u32 s34, 98304
    s_cselect_b32 s34, 0, s34
    s_sub_u32 s39, s39, 1
    s_cmp_lg_u32 s39, 0
    s_cbranch_scc1 g1_lloopA
    s_waitcnt vmcnt(0)
    s_barrier
    s_endpgm
.section .rodata,"a"
.p2align 6
.amdhsa_kernel gemm1_kernel
  .amdhsa_next_free_vgpr 168
  .amdhsa_next_free_sgpr 70
  .amdhsa_accum_offset 168
  .amdhsa_group_segment_fixed_size 0
  .amdhsa_kernarg_size 104
  .amdhsa_user_sgpr_count 2
  .amdhsa_user_sgpr_kernarg_segment_ptr 1
  .amdhsa_system_sgpr_workgroup_id_x 1
.end_amdhsa_kernel
.text
.globl attn_kernel
.p2align 8
.type attn_kernel,@function
attn_kernel:
    s_load_dwordx2 s[10:11], s[0:1], 96
    s_load_dwordx2 s[4:5], s[0:1], 56
    s_load_dwordx2 s[6:7], s[0:1], 72
    s_load_dwordx2 s[8:9], s[0:1], 32
    s_cmp_ge_u32 s2, 256
    s_cbranch_scc1 at_done
    v_lshrrev_b32 v1, 6, v0
    s_nop 0
    v_readfirstlane_b32 s30, v1
    v_and_b32 v1, 63, v0
    s_lshl_b32 s31, s2, 3
    s_and_b32 s29, s30, 7
    s_add_u32 s31, s31, s29
    s_lshr_b32 s28, s30, 3
    s_waitcnt lgkmcnt(0)

    s_add_u32 s12, s10, 0x4c0000
    s_addc_u32 s13, s11, 0
    s_and_b32 s13, s13, 0xffff
    s_mov_b32 s14, 0x26000
    s_mov_b32 s15, 0x00020000
    s_add_u32 s16, s10, 0x280000
    s_addc_u32 s17, s11, 0
    s_and_b32 s17, s17, 0xffff
    s_mov_b32 s18, 0x240000
    s_mov_b32 s19, 0x00020000
    s_add_u32 s20, s10, 0x1700000
    s_addc_u32 s21, s11, 0
    s_and_b32 s21, s21, 0xffff
    s_mov_b32 s22, 0xb40000
    s_mov_b32 s23, 0x00020000
    s_add_u32 s24, s10, 0x500000
    s_addc_u32 s25, s11, 0
    s_and_b32 s25, s25, 0xffff
    s_mov_b32 s26, 0x1200000
    s_mov_b32 s27, 0x00020000
    s_add_u32 s48, s10, 0x2300000
    s_addc_u32 s49, s11, 0
    s_and_b32 s49, s49, 0xffff
    s_mov_b32 s50, 0x900000
    s_mov_b32 s51, 0x00020000
    s_mov_b32 s52, s4
    s_and_b32 s53, s5, 0xffff
    s_mov_b32 s54, 0x800000
    s_mov_b32 s55, 0x00020000
    v_and_b32 v5, 31, v1
    v_lshrrev_b32 v6, 5, v1
    v_mul_u32_u24 v24, 36, v5
    v_lshl_add_u32 v25, v6, 4, v24
    s_mul_i32 s33, s31, 1152
    buffer_load_dwordx4 v[16:19], v25, s[16:19], s33 offen
    buffer_load_dword v20, v24, s[16:19], s33 offen offset:32
    v_lshlrev_b32 v2, 4, v1

    s_mul_i32 s34, s29, 10240
    s_mul_i32 s35, s29, 9216
    s_add_u32 s35, s35, 81920
    s_cmp_eq_u32 s28, 0
    s_cselect_b32 s34, s34, s35

    s_add_u32 s35, s34, 0
    s_mov_b32 m0, s35
    s_nop 0
    buffer_load_dwordx4 v2, s[12:15], s35 offen lds
    s_add_u32 s35, s34, 1024
    s_mov_b32 m0, s35
    s_nop 0
    buffer_load_dwordx4 v2, s[12:15], s35 offen lds
    s_add_u32 s35, s34, 2048
    s_mov_b32 m0, s35
    s_nop 0
    buffer_load_dwordx4 v2, s[12:15], s35 offen lds
    s_add_u32 s35, s34, 3072
    s_mov_b32 m0, s35
    s_nop 0
    buffer_load_dwordx4 v2, s[12:15], s35 offen lds
    s_add_u32 s35, s34, 4096
    s_mov_b32 m0, s35
    s_nop 0
    buffer_load_dwordx4 v2, s[12:15], s35 offen lds
    s_add_u32 s35, s34, 5120
    s_mov_b32 m0, s35
    s_nop 0
    buffer_load_dwordx4 v2, s[12:15], s35 offen lds
    s_add_u32 s35, s34, 6144
    s_mov_b32 m0, s35
    s_nop 0
    buffer_load_dwordx4 v2, s[12:15], s35 offen lds
    s_add_u32 s35, s34, 7168
    s_mov_b32 m0, s35
    s_nop 0
    buffer_load_dwordx4 v2, s[12:15], s35 offen lds
    s_add_u32 s35, s34, 8192
    s_mov_b32 m0, s35
    s_cmp_eq_u32 s28, 0
    buffer_load_dwordx4 v2, s[12:15], s35 offen lds
    s_cbranch_scc0 at_dmadone
    s_add_u32 s35, s34, 9216
    s_mov_b32 m0, s35
    s_nop 0
    buffer_load_dwordx4 v2, s[12:15], s35 offen lds
at_dmadone:
    s_waitcnt vmcnt(0)
    v_cmp_eq_u32 vcc, 0, v6
    v_mov_b32 v21, 0
    v_mov_b32 v22, 0
    v_cndmask_b32 v20, 0, v20, vcc
    v_mov_b32 v23, 0
    s_mov_b32 s46, 0x00000000
    s_mov_b32 s47, 0x4e800000
    s_mov_b32 s56, 0
    s_mov_b32 s57, 0
    s_mov_b32 s44, 124276

    s_barrier
    v_mov_b32 v113, 0
    v_mov_b32 v114, 0
    v_mov_b32 v115, 0
    v_mov_b32 v117, 0
    v_mov_b32 v118, 0
    v_mov_b32 v119, 0
    s_mov_b32 s58, -1
at_restart:
    s_add_u32 s58, s58, 1
    s_lshl_b32 s36, s28, 15
    v_lshlrev_b32 v2, 4, v1
    v_add_u32 v2, s36, v2
    s_lshl_b32 s36, s28, 12
    s_add_u32 s36, s36, 0x10000
    v_lshlrev_b32 v3, 2, v5
    v_add_u32 v3, s36, v3
    s_mul_i32 s36, s28, 40960
    s_add_u32 s36, s36, 73728
    v_min_u32 v4, 19, v5
    v_lshlrev_b32 v4, 4, v4
    v_mul_u32_u24 v7, 320, v6
    v_add3_u32 v4, v4, v7, s36

    v_mov_b32 v48, 0
    v_mov_b32 v49, 0
    v_mov_b32 v50, 0
    v_mov_b32 v51, 0
    v_mov_b32 v52, 0
    v_mov_b32 v53, 0
    v_mov_b32 v54, 0
    v_mov_b32 v55, 0
    v_mov_b32 v56, 0
    v_mov_b32 v57, 0
    v_mov_b32 v58, 0
    v_mov_b32 v59, 0
    v_mov_b32 v60, 0
    v_mov_b32 v61, 0
    v_mov_b32 v62, 0
    v_mov_b32 v63, 0
    v_mov_b32 v29, 0xff800000
    ds_read_b128 v[108:111], v2 offset:1024
    ds_read_b32 v116, v3 offset:128
    ds_read_b128 v[104:107], v2 offset:0
    ds_read_b32 v112, v3 offset:0
    s_waitcnt lgkmcnt(2)
    v_mfma_f32_32x32x16_bf16 v[80:95], v[108:111], v[16:19], 0
    v_mfma_f32_32x32x16_bf16 v[80:95], v[116:119], v[20:23], v[80:95]
    s_nop 15
    v_max3_f32 v24, v80, v81, v82
    v_max3_f32 v25, v83, v84, v85
    v_max3_f32 v26, v86, v87, v88
    v_max3_f32 v27, v89, v90, v91
    v_max3_f32 v28, v92, v93, v94
    v_max3_f32 v24, v24, v25, v26
    v_max3_f32 v27, v27, v28, v95
    v_max_f32 v24, v24, v27
    v_max_f32 v29, v29, v24
    s_waitcnt lgkmcnt(0)
    v_mfma_f32_32x32x16_bf16 v[64:79], v[104:107], v[16:19], 0
    v_mfma_f32_32x32x16_bf16 v[64:79], v[112:115], v[20:23], v[64:79]
    ds_read_b128 v[108:111], v2 offset:1024
    ds_read_b32 v116, v3 offset:128
    ds_read_b128 v[120:123], v4 offset:0
    ds_read_b128 v[124:127], v4 offset:640
    s_nop 15
    v_max3_f32 v24, v64, v65, v66
    v_max3_f32 v25, v67, v68, v69
    v_max3_f32 v26, v70, v71, v72
    v_max3_f32 v27, v73, v74, v75
    v_max3_f32 v28, v76, v77, v78
    v_max3_f32 v24, v24, v25, v26
    v_max3_f32 v27, v27, v28, v79
    v_max_f32 v24, v24, v27
    v_max_f32 v29, v29, v24
    v_mov_b32 v24, v29
    v_mov_b32 v25, v24
    s_nop 1
    v_permlane32_swap_b32 v24, v25
    s_nop 1
    v_max_f32 v24, v24, v25
    v_add_f32 v24, 0x42800000, v24
    v_sub_f32 v32, 0, v24
    v_sub_f32 v33, 0, v24
    v_sub_f32 v34, 0, v24
    v_sub_f32 v35, 0, v24
    v_sub_f32 v36, 0, v24
    v_sub_f32 v37, 0, v24
    v_sub_f32 v38, 0, v24
    v_sub_f32 v39, 0, v24
    v_sub_f32 v40, 0, v24
    v_sub_f32 v41, 0, v24
    v_sub_f32 v42, 0, v24
    v_sub_f32 v43, 0, v24
    v_sub_f32 v44, 0, v24
    v_sub_f32 v45, 0, v24
    v_sub_f32 v46, 0, v24
    v_sub_f32 v47, 0, v24
    v_sub_f32 v64, v64, v24
    v_sub_f32 v65, v65, v24
    v_sub_f32 v66, v66, v24
    v_sub_f32 v67, v67, v24
    v_sub_f32 v68, v68, v24
    v_sub_f32 v69, v69, v24
    v_sub_f32 v70, v70, v24
    v_sub_f32 v71, v71, v24
    v_sub_f32 v72, v72, v24
    v_sub_f32 v73, v73, v24
    v_sub_f32 v74, v74, v24
    v_sub_f32 v75, v75, v24
    v_sub_f32 v76, v76, v24
    v_sub_f32 v77, v77, v24
    v_sub_f32 v78, v78, v24
    v_sub_f32 v79, v79, v24
    s_mov_b32 s45, 16
    s_cmp_lg_u32 s56, 0
    s_cbranch_scc1 at_loopC
    v_mov_b32 v8, 0
    v_mov_b32 v9, 0
    v_mov_b32 v10, 0
    v_mov_b32 v11, 0
    v_mov_b32 v12, 0
    v_mov_b32 v13, 0
    v_mov_b32 v14, 0
    v_mov_b32 v15, 0
    s_waitcnt lgkmcnt(0)
    ds_read_b128 v[104:107], v2 offset:1024
    ds_read_b32 v112, v3 offset:128
    ds_read_b128 v[120:123], v4 offset:0
    ds_read_b128 v[124:127], v4 offset:640
at_loopF:
    s_nop 0
    v_cmp_lt_f32 vcc, s47, v58
    s_cbranch_vccnz at_rareF0
at_backF0:
    s_waitcnt lgkmcnt(2)
    v_mfma_f32_32x32x16_bf16 v[80:95], v[104:107], v[16:19], v[32:47]
    v_exp_f32 v64, v64
    v_exp_f32 v65, v65
    v_exp_f32 v66, v66
    v_exp_f32 v67, v67
    v_mfma_f32_32x32x16_bf16 v[80:95], v[112:115], v[20:23], v[80:95]
    ds_read_b128 v[104:107], v2 offset:2048
    ds_read_b32 v112, v3 offset:256
    v_cvt_pk_bf16_f32 v96, v64, v65
    v_exp_f32 v68, v68
    v_cvt_pk_bf16_f32 v97, v66, v67
    v_exp_f32 v69, v69
    v_exp_f32 v70, v70
    v_exp_f32 v71, v71
    s_waitcnt lgkmcnt(2)
    v_mfma_f32_32x32x16_bf16 v[48:63], v[120:123], v[8:11], v[48:63]
    v_cvt_pk_bf16_f32 v98, v68, v69
    v_exp_f32 v72, v72
    v_cvt_pk_bf16_f32 v99, v70, v71
    v_exp_f32 v73, v73
    v_exp_f32 v74, v74
    v_exp_f32 v75, v75
    v_mfma_f32_32x32x16_bf16 v[48:63], v[124:127], v[12:15], v[48:63]
    ds_read_b128 v[120:123], v4 offset:0
    ds_read_b128 v[124:127], v4 offset:640
    v_cvt_pk_bf16_f32 v100, v72, v73
    v_exp_f32 v76, v76
    v_cvt_pk_bf16_f32 v101, v74, v75
    v_exp_f32 v77, v77
    v_exp_f32 v78, v78
    v_exp_f32 v79, v79
    v_cvt_pk_bf16_f32 v102, v76, v77
    v_cvt_pk_bf16_f32 v103, v78, v79
    s_nop 3
    v_cmp_lt_f32 vcc, s47, v58
    s_cbranch_vccnz at_rareF1
at_backF1:
    s_waitcnt lgkmcnt(2)
    v_mfma_f32_32x32x16_bf16 v[64:79], v[104:107], v[16:19], v[32:47]
    v_exp_f32 v80, v80
    v_exp_f32 v81, v81
    v_exp_f32 v82, v82
    v_exp_f32 v83, v83
    v_mfma_f32_32x32x16_bf16 v[64:79], v[112:115], v[20:23], v[64:79]
    ds_read_b128 v[104:107], v2 offset:3072
    ds_read_b32 v112, v3 offset:384
    v_cvt_pk_bf16_f32 v8, v80, v81
    v_exp_f32 v84, v84
    v_cvt_pk_bf16_f32 v9, v82, v83
    v_exp_f32 v85, v85
    v_exp_f32 v86, v86
    v_exp_f32 v87, v87
    s_waitcnt lgkmcnt(2)
    v_mfma_f32_32x32x16_bf16 v[48:63], v[120:123], v[96:99], v[48:63]
    v_cvt_pk_bf16_f32 v10, v84, v85
    v_exp_f32 v88, v88
    v_cvt_pk_bf16_f32 v11, v86, v87
    v_exp_f32 v89, v89
    v_exp_f32 v90, v90
    v_exp_f32 v91, v91
    v_mfma_f32_32x32x16_bf16 v[48:63], v[124:127], v[100:103], v[48:63]
    ds_read_b128 v[120:123], v4 offset:1280
    ds_read_b128 v[124:127], v4 offset:1920
    v_cvt_pk_bf16_f32 v12, v88, v89
    v_exp_f32 v92, v92
    v_cvt_pk_bf16_f32 v13, v90, v91
    v_exp_f32 v93, v93
    v_exp_f32 v94, v94
    v_exp_f32 v95, v95
    v_cvt_pk_bf16_f32 v14, v92, v93
    v_cvt_pk_bf16_f32 v15, v94, v95
    v_add_u32 v2, 2048, v2
    v_add_u32 v3, 256, v3
    v_add_u32 v4, 2560, v4
    s_sub_u32 s45, s45, 1
    s_cmp_lg_u32 s45, 0
    s_cbranch_scc1 at_loopF
    s_waitcnt lgkmcnt(0)

    v_mfma_f32_32x32x16_bf16 v[48:63], v[120:123], v[8:11], v[48:63]
    v_mfma_f32_32x32x16_bf16 v[48:63], v[124:127], v[12:15], v[48:63]
    s_branch at_fin
at_loopC:
    s_waitcnt lgkmcnt(2)
    v_mfma_f32_32x32x16_bf16 v[80:95], v[108:111], v[16:19], v[32:47]
    v_mfma_f32_32x32x16_bf16 v[80:95], v[116:119], v[20:23], v[80:95]
    ds_read_b128 v[104:107], v2 offset:2048
    ds_read_b32 v112, v3 offset:256
    ds_read_b128 v[8:11], v4 offset:1280
    ds_read_b128 v[12:15], v4 offset:1920
    v_max3_f32 v24, v64, v65, v66
    v_max3_f32 v25, v67, v68, v69
    v_max3_f32 v26, v70, v71, v72
    v_max3_f32 v27, v73, v74, v75
    v_max3_f32 v28, v76, v77, v78
    v_max3_f32 v24, v24, v25, v26
    v_max3_f32 v27, v27, v28, v79
    v_max_f32 v24, v24, v27
    v_cmp_lt_f32 vcc, s46, v24
    s_cbranch_vccnz at_rareC0
at_backC0:
    v_exp_f32 v64, v64
    v_exp_f32 v65, v65
    v_exp_f32 v66, v66
    v_exp_f32 v67, v67
    v_cvt_pk_bf16_f32 v96, v64, v65
    v_exp_f32 v68, v68
    v_exp_f32 v69, v69
    v_cvt_pk_bf16_f32 v97, v66, v67
    v_exp_f32 v70, v70
    v_exp_f32 v71, v71
    v_cvt_pk_bf16_f32 v98, v68, v69
    v_exp_f32 v72, v72
    v_exp_f32 v73, v73
    v_cvt_pk_bf16_f32 v99, v70, v71
    v_exp_f32 v74, v74
    v_exp_f32 v75, v75
    v_cvt_pk_bf16_f32 v100, v72, v73
    v_exp_f32 v76, v76
    v_exp_f32 v77, v77
    v_cvt_pk_bf16_f32 v101, v74, v75
    v_exp_f32 v78, v78
    v_exp_f32 v79, v79
    v_cvt_pk_bf16_f32 v102, v76, v77
    s_nop 0
    v_cvt_pk_bf16_f32 v103, v78, v79
    s_waitcnt lgkmcnt(4)
    v_mfma_f32_32x32x16_bf16 v[48:63], v[120:123], v[96:99], v[48:63]
    v_mfma_f32_32x32x16_bf16 v[48:63], v[124:127], v[100:103], v[48:63]
    s_waitcnt lgkmcnt(2)
    v_mfma_f32_32x32x16_bf16 v[64:79], v[104:107], v[16:19], v[32:47]
    v_mfma_f32_32x32x16_bf16 v[64:79], v[112:115], v[20:23], v[64:79]
    ds_read_b128 v[108:111], v2 offset:3072
    ds_read_b32 v116, v3 offset:384
    ds_read_b128 v[120:123], v4 offset:2560
    ds_read_b128 v[124:127], v4 offset:3200
    v_max3_f32 v24, v80, v81, v82
    v_max3_f32 v25, v83, v84, v85
    v_max3_f32 v26, v86, v87, v88
    v_max3_f32 v27, v89, v90, v91
    v_max3_f32 v28, v92, v93, v94
    v_max3_f32 v24, v24, v25, v26
    v_max3_f32 v27, v27, v28, v95
    v_max_f32 v24, v24, v27
    v_cmp_lt_f32 vcc, s46, v24
    s_cbranch_vccnz at_rareC1
at_backC1:
    v_exp_f32 v80, v80
    v_exp_f32 v81, v81
    v_exp_f32 v82, v82
    v_exp_f32 v83, v83
    v_cvt_pk_bf16_f32 v96, v80, v81
    v_exp_f32 v84, v84
    v_exp_f32 v85, v85
    v_cvt_pk_bf16_f32 v97, v82, v83
    v_exp_f32 v86, v86
    v_exp_f32 v87, v87
    v_cvt_pk_bf16_f32 v98, v84, v85
    v_exp_f32 v88, v88
    v_exp_f32 v89, v89
    v_cvt_pk_bf16_f32 v99, v86, v87
    v_exp_f32 v90, v90
    v_exp_f32 v91, v91
    v_cvt_pk_bf16_f32 v100, v88, v89
    v_exp_f32 v92, v92
    v_exp_f32 v93, v93
    v_cvt_pk_bf16_f32 v101, v90, v91
    v_exp_f32 v94, v94
    v_exp_f32 v95, v95
    v_cvt_pk_bf16_f32 v102, v92, v93
    s_nop 0
    v_cvt_pk_bf16_f32 v103, v94, v95
    s_waitcnt lgkmcnt(4)
    v_mfma_f32_32x32x16_bf16 v[48:63], v[8:11], v[96:99], v[48:63]
    v_mfma_f32_32x32x16_bf16 v[48:63], v[12:15], v[100:103], v[48:63]
    v_add_u32 v2, 2048, v2
    v_add_u32 v3, 256, v3
    v_add_u32 v4, 2560, v4
    s_sub_u32 s45, s45, 1
    s_cmp_lg_u32 s45, 0
    s_cbranch_scc1 at_loopC

at_fin:
    s_nop 15
    s_waitcnt lgkmcnt(0)
    s_cmp_lg_u32 s56, 0
    s_cbranch_scc1 at_merge
    v_add_f32 v24, |v48|, |v49|
    v_add_f32 v24, v24, |v50|
    v_add_f32 v24, v24, |v51|
    v_add_f32 v24, v24, |v52|
    v_add_f32 v24, v24, |v53|
    v_add_f32 v24, v24, |v54|
    v_add_f32 v24, v24, |v55|
    v_add_f32 v24, v24, |v56|
    v_add_f32 v24, v24, |v57|
    v_add_f32 v24, v24, |v58|
    v_mov_b32 v25, 0x7d800000
    v_cmp_nlt_f32 vcc, v24, v25
    s_mov_b32 s56, 1
    s_cbranch_vccnz at_restart
at_merge:
    s_cmp_lg_u32 s28, 0
    s_cbranch_scc1 at_noln2
    s_mul_i32 s32, s31, 9216
    s_add_u32 s32, s32, 4608
    v_lshlrev_b32 v26, 3, v1
    v_add_u32 v27, 0x1000, v26
    v_lshlrev_b32 v2, 4, v1

    buffer_load_dwordx2 v[64:65], v26, s[24:27], s32 offen offset:0
    buffer_load_dwordx2 v[66:67], v26, s[24:27], s32 offen offset:512
    buffer_load_dwordx2 v[68:69], v26, s[24:27], s32 offen offset:1024
    buffer_load_dwordx2 v[70:71], v26, s[24:27], s32 offen offset:1536
    buffer_load_dwordx2 v[72:73], v26, s[24:27], s32 offen offset:2048
    buffer_load_dwordx2 v[74:75], v26, s[24:27], s32 offen offset:2560
    buffer_load_dwordx2 v[76:77], v26, s[24:27], s32 offen offset:3072
    buffer_load_dwordx2 v[78:79], v26, s[24:27], s32 offen offset:3584
    buffer_load_dwordx2 v[80:81], v27, s[24:27], s32 offen
    s_and_b32 s36, s2, 3
    s_lshl_b32 s36, s36, 21
    s_lshr_b32 s37, s2, 3
    s_lshl_b32 s37, s37, 16
    s_add_u32 s36, s36, s37
    s_lshl_b32 s37, s29, 13
    s_add_u32 s36, s36, s37

    s_lshl_b32 s37, s29, 10
    s_add_u32 m0, s37, 155648
    s_add_u32 s37, s36, 0
    buffer_load_dwordx4 v2, s[52:55], s37 offen lds
    s_add_u32 s37, s36, 1024
    buffer_load_dwordx4 v2, s[52:55], s37 offen lds
    s_add_u32 s37, s36, 2048
    buffer_load_dwordx4 v2, s[52:55], s37 offen lds
    s_add_u32 s37, s36, 3072
    buffer_load_dwordx4 v2, s[52:55], s37 offen lds
    s_add_u32 s37, s36, 4096
    buffer_load_dwordx4 v2, s[52:55], s37 offen lds
    s_add_u32 s37, s36, 5120
    buffer_load_dwordx4 v2, s[52:55], s37 offen lds
    s_add_u32 s37, s36, 6144
    buffer_load_dwordx4 v2, s[52:55], s37 offen lds
    s_add_u32 s37, s36, 7168
    buffer_load_dwordx4 v2, s[52:55], s37 offen lds
    s_mov_b32 s52, s6
    s_and_b32 s53, s7, 0xffff
    s_mov_b32 s54, 0x288000
    s_mov_b32 s55, 0x00020000
    s_mov_b32 s60, s8
    s_and_b32 s61, s9, 0xffff
    s_mov_b32 s62, 0xa2000
    s_mov_b32 s63, 0x00020000
    s_add_u32 s64, s10, 0x2c00000
    s_addc_u32 s65, s11, 0
    s_and_b32 s65, s65, 0xffff
    s_mov_b32 s66, 0x32a000
    s_mov_b32 s67, 0x00020000
    s_mul_i32 s36, s2, 810
    s_lshl_b32 s37, s29, 7
    s_mov_b32 s38, 31069
    s_mov_b32 s39, 34560
    v_add_u32 v24, 0, v1
    v_add_u32 v24, s37, v24
    v_cmp_gt_u32 vcc, 810, v24
    v_add_u32 v24, s36, v24
    v_mul_hi_u32 v25, v24, s44
    v_mul_lo_u32 v26, v25, s39
    v_sub_u32 v26, v24, v26
    v_mul_u32_u24 v27, 43691, v26
    v_lshrrev_b32 v27, 24, v27
    v_mul_u32_u24 v28, 384, v27
    v_sub_u32 v26, v26, v28
    v_mul_u32_u24 v28, 5462, v26
    v_lshrrev_b32 v28, 16, v28
    v_mul_u32_u24 v29, 12, v28
    v_sub_u32 v26, v26, v29
    v_bfe_u32 v29, v28, 2, 1
    v_lshlrev_b32 v29, 1, v29
    v_xor_b32 v26, v26, v29
    v_bfe_u32 v29, v28, 2, 2
    v_lshlrev_b32 v29, 3, v29
    v_lshrrev_b32 v30, 4, v28
    v_lshl_add_u32 v29, v30, 2, v29
    v_and_b32 v28, 3, v28
    v_add_u32 v28, v28, v29
    v_lshl_add_u32 v28, v27, 5, v28
    v_mul_u32_u24 v28, 1152, v28
    v_mul_u32_u24 v25, 192, v25
    v_lshl_add_u32 v25, v26, 4, v25
    v_add_u32 v28, v28, v25
    v_subrev_u32 v29, 663552, v28
    buffer_load_dwordx4 v[8:11], v28, s[60:63], 0 offen
    buffer_load_dwordx4 v[12:15], v29, s[52:55], 0 offen
    v_lshlrev_b32 v24, 4, v24
    v_mov_b32 v25, 0x7fffffff
    v_cndmask_b32 v120, v25, v24, vcc
    v_add_u32 v24, 64, v1
    v_add_u32 v24, s37, v24
    v_cmp_gt_u32 vcc, 810, v24
    v_add_u32 v24, s36, v24
    v_mul_hi_u32 v25, v24, s44
    v_mul_lo_u32 v26, v25, s39
    v_sub_u32 v26, v24, v26
    v_mul_u32_u24 v27, 43691, v26
    v_lshrrev_b32 v27, 24, v27
    v_mul_u32_u24 v28, 384, v27
    v_sub_u32 v26, v26, v28
    v_mul_u32_u24 v28, 5462, v26
    v_lshrrev_b32 v28, 16, v28
    v_mul_u32_u24 v29, 12, v28
    v_sub_u32 v26, v26, v29
    v_bfe_u32 v29, v28, 2, 1
    v_lshlrev_b32 v29, 1, v29
    v_xor_b32 v26, v26, v29
    v_bfe_u32 v29, v28, 2, 2
    v_lshlrev_b32 v29, 3, v29
    v_lshrrev_b32 v30, 4, v28
    v_lshl_add_u32 v29, v30, 2, v29
    v_and_b32 v28, 3, v28
    v_add_u32 v28, v28, v29
    v_lshl_add_u32 v28, v27, 5, v28
    v_mul_u32_u24 v28, 1152, v28
    v_mul_u32_u24 v25, 192, v25
    v_lshl_add_u32 v25, v26, 4, v25
    v_add_u32 v28, v28, v25
    v_subrev_u32 v29, 663552, v28
    buffer_load_dwordx4 v[16:19], v28, s[60:63], 0 offen
    buffer_load_dwordx4 v[20:23], v29, s[52:55], 0 offen
    v_lshlrev_b32 v24, 4, v24
    v_mov_b32 v25, 0x7fffffff
    v_cndmask_b32 v121, v25, v24, vcc
    s_waitcnt vmcnt(12)
    v_lshlrev_b32 v82, 16, v64
    v_and_b32 v83, 0xffff0000, v64
    v_lshlrev_b32 v84, 16, v65
    v_and_b32 v85, 0xffff0000, v65
    v_lshlrev_b32 v86, 16, v66
    v_and_b32 v87, 0xffff0000, v66
    v_lshlrev_b32 v88, 16, v67
    v_and_b32 v89, 0xffff0000, v67
    v_lshlrev_b32 v90, 16, v68
    v_and_b32 v91, 0xffff0000, v68
    v_lshlrev_b32 v92, 16, v69
    v_and_b32 v93, 0xffff0000, v69
    v_lshlrev_b32 v94, 16, v70
    v_and_b32 v95, 0xffff0000, v70
    v_lshlrev_b32 v96, 16, v71
    v_and_b32 v97, 0xffff0000, v71
    v_lshlrev_b32 v98, 16, v72
    v_and_b32 v99, 0xffff0000, v72
    v_lshlrev_b32 v100, 16, v73
    v_and_b32 v101, 0xffff0000, v73
    v_lshlrev_b32 v102, 16, v74
    v_and_b32 v103, 0xffff0000, v74
    v_lshlrev_b32 v104, 16, v75
    v_and_b32 v105, 0xffff0000, v75
    v_lshlrev_b32 v106, 16, v76
    v_and_b32 v107, 0xffff0000, v76
    v_lshlrev_b32 v108, 16, v77
    v_and_b32 v109, 0xffff0000, v77
    v_lshlrev_b32 v110, 16, v78
    v_and_b32 v111, 0xffff0000, v78
    v_lshlrev_b32 v112, 16, v79
    v_and_b32 v113, 0xffff0000, v79
    v_lshlrev_b32 v114, 16, v80
    v_and_b32 v115, 0xffff0000, v80
    v_lshlrev_b32 v116, 16, v81
    v_and_b32 v117, 0xffff0000, v81
    v_add_f32 v24, v82, v83
    v_add_f32 v24, v24, v84
    v_add_f32 v24, v24, v85
    v_add_f32 v24, v24, v86
    v_add_f32 v24, v24, v87
    v_add_f32 v24, v24, v88
    v_add_f32 v24, v24, v89
    v_add_f32 v24, v24, v90
    v_add_f32 v24, v24, v91
    v_add_f32 v24, v24, v92
    v_add_f32 v24, v24, v93
    v_add_f32 v24, v24, v94
    v_add_f32 v24, v24, v95
    v_add_f32 v24, v24, v96
    v_add_f32 v24, v24, v97
    v_add_f32 v24, v24, v98
    v_add_f32 v24, v24, v99
    v_add_f32 v24, v24, v100
    v_add_f32 v24, v24, v101
    v_add_f32 v24, v24, v102
    v_add_f32 v24, v24, v103
    v_add_f32 v24, v24, v104
    v_add_f32 v24, v24, v105
    v_add_f32 v24, v24, v106
    v_add_f32 v24, v24, v107
    v_add_f32 v24, v24, v108
    v_add_f32 v24, v24, v109
    v_add_f32 v24, v24, v110
    v_add_f32 v24, v24, v111
    v_add_f32 v24, v24, v112
    v_add_f32 v24, v24, v113
    v_add_f32 v24, v24, v114
    v_add_f32 v24, v24, v115
    v_add_f32 v24, v24, v116
    v_add_f32 v24, v24, v117
    s_nop 1
    v_add_f32_dpp v25, v24, v24 row_ror:8 row_mask:0xf bank_mask:0xf
    v_mov_b32 v24, v25
    s_nop 1
    v_add_f32_dpp v25, v24, v24 row_ror:4 row_mask:0xf bank_mask:0xf
    v_mov_b32 v24, v25
    s_nop 1
    v_add_f32_dpp v25, v24, v24 row_ror:2 row_mask:0xf bank_mask:0xf
    v_mov_b32 v24, v25
    s_nop 1
    v_add_f32_dpp v25, v24, v24 row_ror:1 row_mask:0xf bank_mask:0xf
    v_mov_b32 v24, v25
    s_nop 0
    v_readlane_b32 s40, v24, 0
    v_readlane_b32 s41, v24, 16
    v_readlane_b32 s42, v24, 32
    v_readlane_b32 s43, v24, 48
    s_nop 1
    v_mov_b32 v24, s40
    v_add_f32 v24, s41, v24
    v_add_f32 v24, s42, v24
    v_add_f32 v24, s43, v24
    v_mul_f32 v26, 0x39e38e39, v24
    v_sub_f32 v25, v82, v26
    v_mul_f32 v24, v25, v25
    v_sub_f32 v25, v83, v26
    v_fmac_f32 v24, v25, v25
    v_sub_f32 v25, v84, v26
    v_fmac_f32 v24, v25, v25
    v_sub_f32 v25, v85, v26
    v_fmac_f32 v24, v25, v25
    v_sub_f32 v25, v86, v26
    v_fmac_f32 v24, v25, v25
    v_sub_f32 v25, v87, v26
    v_fmac_f32 v24, v25, v25
    v_sub_f32 v25, v88, v26
    v_fmac_f32 v24, v25, v25
    v_sub_f32 v25, v89, v26
    v_fmac_f32 v24, v25, v25
    v_sub_f32 v25, v90, v26
    v_fmac_f32 v24, v25, v25
    v_sub_f32 v25, v91, v26
    v_fmac_f32 v24, v25, v25
    v_sub_f32 v25, v92, v26
    v_fmac_f32 v24, v25, v25
    v_sub_f32 v25, v93, v26
    v_fmac_f32 v24, v25, v25
    v_sub_f32 v25, v94, v26
    v_fmac_f32 v24, v25, v25
    v_sub_f32 v25, v95, v26
    v_fmac_f32 v24, v25, v25
    v_sub_f32 v25, v96, v26
    v_fmac_f32 v24, v25, v25
    v_sub_f32 v25, v97, v26
    v_fmac_f32 v24, v25, v25
    v_sub_f32 v25, v98, v26
    v_fmac_f32 v24, v25, v25
    v_sub_f32 v25, v99, v26
    v_fmac_f32 v24, v25, v25
    v_sub_f32 v25, v100, v26
    v_fmac_f32 v24, v25, v25
    v_sub_f32 v25, v101, v26
    v_fmac_f32 v24, v25, v25
    v_sub_f32 v25, v102, v26
    v_fmac_f32 v24, v25, v25
    v_sub_f32 v25, v103, v26
    v_fmac_f32 v24, v25, v25
    v_sub_f32 v25, v104, v26
    v_fmac_f32 v24, v25, v25
    v_sub_f32 v25, v105, v26
    v_fmac_f32 v24, v25, v25
    v_sub_f32 v25, v106, v26
    v_fmac_f32 v24, v25, v25
    v_sub_f32 v25, v107, v26
    v_fmac_f32 v24, v25, v25
    v_sub_f32 v25, v108, v26
    v_fmac_f32 v24, v25, v25
    v_sub_f32 v25, v109, v26
    v_fmac_f32 v24, v25, v25
    v_sub_f32 v25, v110, v26
    v_fmac_f32 v24, v25, v25
    v_sub_f32 v25, v111, v26
    v_fmac_f32 v24, v25, v25
    v_sub_f32 v25, v112, v26
    v_fmac_f32 v24, v25, v25
    v_sub_f32 v25, v113, v26
    v_fmac_f32 v24, v25, v25
    v_sub_f32 v25, v114, v26
    v_fmac_f32 v24, v25, v25
    v_sub_f32 v25, v115, v26
    v_fmac_f32 v24, v25, v25
    v_sub_f32 v25, v116, v26
    v_fmac_f32 v24, v25, v25
    v_sub_f32 v25, v117, v26
    v_fmac_f32 v24, v25, v25
    s_nop 1
    v_add_f32_dpp v25, v24, v24 row_ror:8 row_mask:0xf bank_mask:0xf
    v_mov_b32 v24, v25
    s_nop 1
    v_add_f32_dpp v25, v24, v24 row_ror:4 row_mask:0xf bank_mask:0xf
    v_mov_b32 v24, v25
    s_nop 1
    v_add_f32_dpp v25, v24, v24 row_ror:2 row_mask:0xf bank_mask:0xf
    v_mov_b32 v24, v25
    s_nop 1
    v_add_f32_dpp v25, v24, v24 row_ror:1 row_mask:0xf bank_mask:0xf
    v_mov_b32 v24, v25
    s_nop 0
    v_readlane_b32 s40, v24, 0
    v_readlane_b32 s41, v24, 16
    v_readlane_b32 s42, v24, 32
    v_readlane_b32 s43, v24, 48
    s_nop 1
    v_mov_b32 v24, s40
    v_add_f32 v24, s41, v24
    v_add_f32 v24, s42, v24
    v_add_f32 v24, s43, v24
    v_mul_f32 v24, 0x39e38e39, v24
    v_cvt_pk_bf16_f32 v24, v24, v24
    v_lshlrev_b32 v24, 16, v24
    v_add_f32 v24, 0x3727c5ac, v24
    v_cvt_pk_bf16_f32 v24, v24, v24
    v_lshlrev_b32 v24, 16, v24
    v_sqrt_f32 v24, v24
    s_nop 0
    v_cvt_pk_bf16_f32 v24, v24, v24
    v_lshlrev_b32 v24, 16, v24
    v_rcp_f32 v27, v24
    v_cvt_pk_bf16_f32 v26, v26, v26
    v_lshlrev_b32 v26, 16, v26
    v_sub_f32 v82, v82, v26
    v_sub_f32 v83, v83, v26
    v_cvt_pk_bf16_f32 v64, v82, v83
    v_lshlrev_b32 v82, 16, v64
    v_and_b32 v83, 0xffff0000, v64
    v_mul_f32 v82, v82, v27
    v_mul_f32 v83, v83, v27
    v_cvt_pk_bf16_f32 v64, v82, v83
    v_sub_f32 v84, v84, v26
    v_sub_f32 v85, v85, v26
    v_cvt_pk_bf16_f32 v65, v84, v85
    v_lshlrev_b32 v84, 16, v65
    v_and_b32 v85, 0xffff0000, v65
    v_mul_f32 v84, v84, v27
    v_mul_f32 v85, v85, v27
    v_cvt_pk_bf16_f32 v65, v84, v85
    v_sub_f32 v86, v86, v26
    v_sub_f32 v87, v87, v26
    v_cvt_pk_bf16_f32 v66, v86, v87
    v_lshlrev_b32 v86, 16, v66
    v_and_b32 v87, 0xffff0000, v66
    v_mul_f32 v86, v86, v27
    v_mul_f32 v87, v87, v27
    v_cvt_pk_bf16_f32 v66, v86, v87
    v_sub_f32 v88, v88, v26
    v_sub_f32 v89, v89, v26
    v_cvt_pk_bf16_f32 v67, v88, v89
    v_lshlrev_b32 v88, 16, v67
    v_and_b32 v89, 0xffff0000, v67
    v_mul_f32 v88, v88, v27
    v_mul_f32 v89, v89, v27
    v_cvt_pk_bf16_f32 v67, v88, v89
    v_sub_f32 v90, v90, v26
    v_sub_f32 v91, v91, v26
    v_cvt_pk_bf16_f32 v68, v90, v91
    v_lshlrev_b32 v90, 16, v68
    v_and_b32 v91, 0xffff0000, v68
    v_mul_f32 v90, v90, v27
    v_mul_f32 v91, v91, v27
    v_cvt_pk_bf16_f32 v68, v90, v91
    v_sub_f32 v92, v92, v26
    v_sub_f32 v93, v93, v26
    v_cvt_pk_bf16_f32 v69, v92, v93
    v_lshlrev_b32 v92, 16, v69
    v_and_b32 v93, 0xffff0000, v69
    v_mul_f32 v92, v92, v27
    v_mul_f32 v93, v93, v27
    v_cvt_pk_bf16_f32 v69, v92, v93
    v_sub_f32 v94, v94, v26
    v_sub_f32 v95, v95, v26
    v_cvt_pk_bf16_f32 v70, v94, v95
    v_lshlrev_b32 v94, 16, v70
    v_and_b32 v95, 0xffff0000, v70
    v_mul_f32 v94, v94, v27
    v_mul_f32 v95, v95, v27
    v_cvt_pk_bf16_f32 v70, v94, v95
    v_sub_f32 v96, v96, v26
    v_sub_f32 v97, v97, v26
    v_cvt_pk_bf16_f32 v71, v96, v97
    v_lshlrev_b32 v96, 16, v71
    v_and_b32 v97, 0xffff0000, v71
    v_mul_f32 v96, v96, v27
    v_mul_f32 v97, v97, v27
    v_cvt_pk_bf16_f32 v71, v96, v97
    v_sub_f32 v98, v98, v26
    v_sub_f32 v99, v99, v26
    v_cvt_pk_bf16_f32 v72, v98, v99
    v_lshlrev_b32 v98, 16, v72
    v_and_b32 v99, 0xffff0000, v72
    v_mul_f32 v98, v98, v27
    v_mul_f32 v99, v99, v27
    v_cvt_pk_bf16_f32 v72, v98, v99
    v_sub_f32 v100, v100, v26
    v_sub_f32 v101, v101, v26
    v_cvt_pk_bf16_f32 v73, v100, v101
    v_lshlrev_b32 v100, 16, v73
    v_and_b32 v101, 0xffff0000, v73
    v_mul_f32 v100, v100, v27
    v_mul_f32 v101, v101, v27
    v_cvt_pk_bf16_f32 v73, v100, v101
    v_sub_f32 v102, v102, v26
    v_sub_f32 v103, v103, v26
    v_cvt_pk_bf16_f32 v74, v102, v103
    v_lshlrev_b32 v102, 16, v74
    v_and_b32 v103, 0xffff0000, v74
    v_mul_f32 v102, v102, v27
    v_mul_f32 v103, v103, v27
    v_cvt_pk_bf16_f32 v74, v102, v103
    v_sub_f32 v104, v104, v26
    v_sub_f32 v105, v105, v26
    v_cvt_pk_bf16_f32 v75, v104, v105
    v_lshlrev_b32 v104, 16, v75
    v_and_b32 v105, 0xffff0000, v75
    v_mul_f32 v104, v104, v27
    v_mul_f32 v105, v105, v27
    v_cvt_pk_bf16_f32 v75, v104, v105
    v_sub_f32 v106, v106, v26
    v_sub_f32 v107, v107, v26
    v_cvt_pk_bf16_f32 v76, v106, v107
    v_lshlrev_b32 v106, 16, v76
    v_and_b32 v107, 0xffff0000, v76
    v_mul_f32 v106, v106, v27
    v_mul_f32 v107, v107, v27
    v_cvt_pk_bf16_f32 v76, v106, v107
    v_sub_f32 v108, v108, v26
    v_sub_f32 v109, v109, v26
    v_cvt_pk_bf16_f32 v77, v108, v109
    v_lshlrev_b32 v108, 16, v77
    v_and_b32 v109, 0xffff0000, v77
    v_mul_f32 v108, v108, v27
    v_mul_f32 v109, v109, v27
    v_cvt_pk_bf16_f32 v77, v108, v109
    v_sub_f32 v110, v110, v26
    v_sub_f32 v111, v111, v26
    v_cvt_pk_bf16_f32 v78, v110, v111
    v_lshlrev_b32 v110, 16, v78
    v_and_b32 v111, 0xffff0000, v78
    v_mul_f32 v110, v110, v27
    v_mul_f32 v111, v111, v27
    v_cvt_pk_bf16_f32 v78, v110, v111
    v_sub_f32 v112, v112, v26
    v_sub_f32 v113, v113, v26
    v_cvt_pk_bf16_f32 v79, v112, v113
    v_lshlrev_b32 v112, 16, v79
    v_and_b32 v113, 0xffff0000, v79
    v_mul_f32 v112, v112, v27
    v_mul_f32 v113, v113, v27
    v_cvt_pk_bf16_f32 v79, v112, v113
    v_sub_f32 v114, v114, v26
    v_sub_f32 v115, v115, v26
    v_cvt_pk_bf16_f32 v80, v114, v115
    v_lshlrev_b32 v114, 16, v80
    v_and_b32 v115, 0xffff0000, v80
    v_mul_f32 v114, v114, v27
    v_mul_f32 v115, v115, v27
    v_cvt_pk_bf16_f32 v80, v114, v115
    v_sub_f32 v116, v116, v26
    v_sub_f32 v117, v117, v26
    v_cvt_pk_bf16_f32 v81, v116, v117
    v_lshlrev_b32 v116, 16, v81
    v_and_b32 v117, 0xffff0000, v81
    v_mul_f32 v116, v116, v27
    v_mul_f32 v117, v117, v27
    v_cvt_pk_bf16_f32 v81, v116, v117
    s_and_b32 s36, s31, 31
    s_lshr_b32 s37, s36, 3
    s_lshl_b32 s37, s37, 2
    s_and_b32 s38, s36, 3
    s_add_u32 s37, s37, s38
    s_bfe_u32 s38, s36, 0x10002
    s_lshl_b32 s38, s38, 4
    s_add_u32 s37, s37, s38
    s_andn2_b32 s36, s31, 31
    s_add_u32 s37, s37, s36
    s_mul_i32 s37, s37, 288
    s_mov_b32 s38, 589824

    v_add_u32 v24, 0, v1
    v_mul_u32_u24 v25, 1821, v24
    v_lshrrev_b32 v25, 16, v25
    v_mul_u32_u24 v26, 36, v25
    v_sub_u32 v26, v24, v26
    v_mul_lo_u32 v25, v25, s38
    v_lshl_add_u32 v25, v26, 3, v25
    buffer_store_dwordx2 v[64:65], v25, s[48:51], s37 offen sc0 sc1
    v_add_u32 v24, 64, v1
    v_mul_u32_u24 v25, 1821, v24
    v_lshrrev_b32 v25, 16, v25
    v_mul_u32_u24 v26, 36, v25
    v_sub_u32 v26, v24, v26
    v_mul_lo_u32 v25, v25, s38
    v_lshl_add_u32 v25, v26, 3, v25
    buffer_store_dwordx2 v[66:67], v25, s[48:51], s37 offen sc0 sc1
    v_add_u32 v24, 128, v1
    v_mul_u32_u24 v25, 1821, v24
    v_lshrrev_b32 v25, 16, v25
    v_mul_u32_u24 v26, 36, v25
    v_sub_u32 v26, v24, v26
    v_mul_lo_u32 v25, v25, s38
    v_lshl_add_u32 v25, v26, 3, v25
    buffer_store_dwordx2 v[68:69], v25, s[48:51], s37 offen sc0 sc1
    v_add_u32 v24, 192, v1
    v_mul_u32_u24 v25, 1821, v24
    v_lshrrev_b32 v25, 16, v25
    v_mul_u32_u24 v26, 36, v25
    v_sub_u32 v26, v24, v26
    v_mul_lo_u32 v25, v25, s38
    v_lshl_add_u32 v25, v26, 3, v25
    buffer_store_dwordx2 v[70:71], v25, s[48:51], s37 offen sc0 sc1
    v_add_u32 v24, 256, v1
    v_mul_u32_u24 v25, 1821, v24
    v_lshrrev_b32 v25, 16, v25
    v_mul_u32_u24 v26, 36, v25
    v_sub_u32 v26, v24, v26
    v_mul_lo_u32 v25, v25, s38
    v_lshl_add_u32 v25, v26, 3, v25
    buffer_store_dwordx2 v[72:73], v25, s[48:51], s37 offen sc0 sc1
    v_add_u32 v24, 320, v1
    v_mul_u32_u24 v25, 1821, v24
    v_lshrrev_b32 v25, 16, v25
    v_mul_u32_u24 v26, 36, v25
    v_sub_u32 v26, v24, v26
    v_mul_lo_u32 v25, v25, s38
    v_lshl_add_u32 v25, v26, 3, v25
    buffer_store_dwordx2 v[74:75], v25, s[48:51], s37 offen sc0 sc1
    v_add_u32 v24, 384, v1
    v_mul_u32_u24 v25, 1821, v24
    v_lshrrev_b32 v25, 16, v25
    v_mul_u32_u24 v26, 36, v25
    v_sub_u32 v26, v24, v26
    v_mul_lo_u32 v25, v25, s38
    v_lshl_add_u32 v25, v26, 3, v25
    buffer_store_dwordx2 v[76:77], v25, s[48:51], s37 offen sc0 sc1
    v_add_u32 v24, 448, v1
    v_mul_u32_u24 v25, 1821, v24
    v_lshrrev_b32 v25, 16, v25
    v_mul_u32_u24 v26, 36, v25
    v_sub_u32 v26, v24, v26
    v_mul_lo_u32 v25, v25, s38
    v_lshl_add_u32 v25, v26, 3, v25
    buffer_store_dwordx2 v[78:79], v25, s[48:51], s37 offen sc0 sc1
    v_add_u32 v24, 512, v1
    v_mul_u32_u24 v25, 1821, v24
    v_lshrrev_b32 v25, 16, v25
    v_mul_u32_u24 v26, 36, v25
    v_sub_u32 v26, v24, v26
    v_mul_lo_u32 v25, v25, s38
    v_lshl_add_u32 v25, v26, 3, v25
    buffer_store_dwordx2 v[80:81], v25, s[48:51], s37 offen sc0 sc1
    s_waitcnt vmcnt(9)
    v_or_b32 v8, v8, v12
    v_or_b32 v9, v9, v13
    v_or_b32 v10, v10, v14
    v_or_b32 v11, v11, v15
    buffer_store_dwordx4 v[8:11], v120, s[64:67], 0 offen sc0 sc1
    v_or_b32 v16, v16, v20
    v_or_b32 v17, v17, v21
    v_or_b32 v18, v18, v22
    v_or_b32 v19, v19, v23
    buffer_store_dwordx4 v[16:19], v121, s[64:67], 0 offen sc0 sc1
at_noln2:
    s_barrier
    s_mul_i32 s36, s29, 3328
    v_lshlrev_b32 v2, 2, v1
    v_add_u32 v2, s36, v2
    s_cmp_eq_u32 s28, 0
    s_cbranch_scc1 at_m0

    ds_write_b32 v2, v48 offset:0
    ds_write_b32 v2, v49 offset:256
    ds_write_b32 v2, v50 offset:512
    ds_write_b32 v2, v51 offset:768
    ds_write_b32 v2, v52 offset:1024
    ds_write_b32 v2, v53 offset:1280
    ds_write_b32 v2, v54 offset:1536
    ds_write_b32 v2, v55 offset:1792
    ds_write_b32 v2, v56 offset:2048
    ds_write_b32 v2, v57 offset:2304
    ds_write_b32 v2, v58 offset:2560
    ds_write_b32 v2, v59 offset:2816
    ds_write_b32 v2, v32 offset:3072
    s_waitcnt lgkmcnt(0)
    s_barrier
    s_endpgm
at_m0:
    s_barrier
    ds_read_b32 v64, v2 offset:0
    ds_read_b32 v65, v2 offset:256
    ds_read_b32 v66, v2 offset:512
    ds_read_b32 v67, v2 offset:768
    ds_read_b32 v68, v2 offset:1024
    ds_read_b32 v69, v2 offset:1280
    ds_read_b32 v70, v2 offset:1536
    ds_read_b32 v71, v2 offset:1792
    ds_read_b32 v72, v2 offset:2048
    ds_read_b32 v73, v2 offset:2304
    ds_read_b32 v74, v2 offset:2560
    ds_read_b32 v75, v2 offset:2816
    ds_read_b32 v76, v2 offset:3072
    s_waitcnt lgkmcnt(0)
    v_min_f32 v24, v32, v76
    v_sub_f32 v25, v24, v32
    v_sub_f32 v26, v24, v76
    v_exp_f32 v25, v25
    v_exp_f32 v26, v26
    s_nop 0

    v_mul_f32 v48, v48, v25
    v_fmac_f32 v48, v64, v26
    v_mul_f32 v49, v49, v25
    v_fmac_f32 v49, v65, v26
    v_mul_f32 v50, v50, v25
    v_fmac_f32 v50, v66, v26
    v_mul_f32 v51, v51, v25
    v_fmac_f32 v51, v67, v26
    v_mul_f32 v52, v52, v25
    v_fmac_f32 v52, v68, v26
    v_mul_f32 v53, v53, v25
    v_fmac_f32 v53, v69, v26
    v_mul_f32 v54, v54, v25
    v_fmac_f32 v54, v70, v26
    v_mul_f32 v55, v55, v25
    v_fmac_f32 v55, v71, v26
    v_mul_f32 v56, v56, v25
    v_fmac_f32 v56, v72, v26
    v_mul_f32 v57, v57, v25
    v_fmac_f32 v57, v73, v26
    v_mul_f32 v58, v58, v25
    v_fmac_f32 v58, v74, v26
    v_mul_f32 v59, v59, v25
    v_fmac_f32 v59, v75, v26
    v_mov_b32 v24, v58
    v_mov_b32 v25, v58
    s_nop 1
    v_permlane32_swap_b32 v24, v25
    s_nop 1
    v_rcp_f32 v24, v24
    s_nop 0

    v_mul_f32 v48, v48, v24
    v_mul_f32 v49, v49, v24
    v_mul_f32 v50, v50, v24
    v_mul_f32 v51, v51, v24
    v_mul_f32 v52, v52, v24
    v_mul_f32 v53, v53, v24
    v_mul_f32 v54, v54, v24
    v_mul_f32 v55, v55, v24
    v_mul_f32 v56, v56, v24
    v_mul_f32 v57, v57, v24
    v_cvt_pk_bf16_f32 v96, v48, v49
    v_cvt_pk_bf16_f32 v97, v50, v51
    v_cvt_pk_bf16_f32 v98, v52, v53
    v_cvt_pk_bf16_f32 v99, v54, v55
    v_cvt_pk_bf16_f32 v100, v56, v57
    v_mul_u32_u24 v24, 36, v5
    v_lshl_add_u32 v7, v6, 3, v24
    s_mul_i32 s33, s31, 5760
    buffer_store_dwordx2 v[96:97], v7, s[20:23], s33 offen
    buffer_store_dwordx2 v[98:99], v7, s[20:23], s33 offen offset:16
    s_mov_b64 exec, 0xffffffff
    buffer_store_dword v100, v7, s[20:23], s33 offen offset:32
    s_mov_b64 exec, -1

    s_endpgm
at_rareC0:
    s_nop 15
    v_mov_b32 v25, v24
    s_nop 1
    v_permlane32_swap_b32 v24, v25
    s_nop 1
    v_max_f32 v24, v24, v25
    v_add_f32 v24, 0x42800000, v24
    v_max_f32 v24, 0, v24
    v_sub_f32 v25, 0, v24
    v_exp_f32 v25, v25
    v_sub_f32 v64, v64, v24
    v_sub_f32 v80, v80, v24
    v_sub_f32 v32, v32, v24
    v_mul_f32 v48, v48, v25
    v_sub_f32 v65, v65, v24
    v_sub_f32 v81, v81, v24
    v_sub_f32 v33, v33, v24
    v_mul_f32 v49, v49, v25
    v_sub_f32 v66, v66, v24
    v_sub_f32 v82, v82, v24
    v_sub_f32 v34, v34, v24
    v_mul_f32 v50, v50, v25
    v_sub_f32 v67, v67, v24
    v_sub_f32 v83, v83, v24
    v_sub_f32 v35, v35, v24
    v_mul_f32 v51, v51, v25
    v_sub_f32 v68, v68, v24
    v_sub_f32 v84, v84, v24
    v_sub_f32 v36, v36, v24
    v_mul_f32 v52, v52, v25
    v_sub_f32 v69, v69, v24
    v_sub_f32 v85, v85, v24
    v_sub_f32 v37, v37, v24
    v_mul_f32 v53, v53, v25
    v_sub_f32 v70, v70, v24
    v_sub_f32 v86, v86, v24
    v_sub_f32 v38, v38, v24
    v_mul_f32 v54, v54, v25
    v_sub_f32 v71, v71, v24
    v_sub_f32 v87, v87, v24
    v_sub_f32 v39, v39, v24
    v_mul_f32 v55, v55, v25
    v_sub_f32 v72, v72, v24
    v_sub_f32 v88, v88, v24
    v_sub_f32 v40, v40, v24
    v_mul_f32 v56, v56, v25
    v_sub_f32 v73, v73, v24
    v_sub_f32 v89, v89, v24
    v_sub_f32 v41, v41, v24
    v_mul_f32 v57, v57, v25
    v_sub_f32 v74, v74, v24
    v_sub_f32 v90, v90, v24
    v_sub_f32 v42, v42, v24
    v_mul_f32 v58, v58, v25
    v_sub_f32 v75, v75, v24
    v_sub_f32 v91, v91, v24
    v_sub_f32 v43, v43, v24
    v_mul_f32 v59, v59, v25
    v_sub_f32 v76, v76, v24
    v_sub_f32 v92, v92, v24
    v_sub_f32 v44, v44, v24
    v_mul_f32 v60, v60, v25
    v_sub_f32 v77, v77, v24
    v_sub_f32 v93, v93, v24
    v_sub_f32 v45, v45, v24
    v_mul_f32 v61, v61, v25
    v_sub_f32 v78, v78, v24
    v_sub_f32 v94, v94, v24
    v_sub_f32 v46, v46, v24
    v_mul_f32 v62, v62, v25
    v_sub_f32 v79, v79, v24
    v_sub_f32 v95, v95, v24
    v_sub_f32 v47, v47, v24
    v_mul_f32 v63, v63, v25
    s_nop 1
    s_branch at_backC0
at_rareF0:
    s_nop 15
    v_mov_b32 v24, v58
    v_mov_b32 v25, v58
    s_nop 1
    v_permlane32_swap_b32 v24, v25
    s_nop 1
    v_log_f32 v24, v24
    s_nop 0
    v_floor_f32 v24, v24
    v_add_f32 v24, 0x42800000, v24
    v_max_f32 v24, 0, v24
    v_min_f32 v24, 0x42f00000, v24
    v_sub_f32 v25, 0, v24
    v_exp_f32 v25, v25
    v_sub_f32 v64, v64, v24
    v_sub_f32 v32, v32, v24
    v_mul_f32 v48, v48, v25
    v_sub_f32 v65, v65, v24
    v_sub_f32 v33, v33, v24
    v_mul_f32 v49, v49, v25
    v_sub_f32 v66, v66, v24
    v_sub_f32 v34, v34, v24
    v_mul_f32 v50, v50, v25
    v_sub_f32 v67, v67, v24
    v_sub_f32 v35, v35, v24
    v_mul_f32 v51, v51, v25
    v_sub_f32 v68, v68, v24
    v_sub_f32 v36, v36, v24
    v_mul_f32 v52, v52, v25
    v_sub_f32 v69, v69, v24
    v_sub_f32 v37, v37, v24
    v_mul_f32 v53, v53, v25
    v_sub_f32 v70, v70, v24
    v_sub_f32 v38, v38, v24
    v_mul_f32 v54, v54, v25
    v_sub_f32 v71, v71, v24
    v_sub_f32 v39, v39, v24
    v_mul_f32 v55, v55, v25
    v_sub_f32 v72, v72, v24
    v_sub_f32 v40, v40, v24
    v_mul_f32 v56, v56, v25
    v_sub_f32 v73, v73, v24
    v_sub_f32 v41, v41, v24
    v_mul_f32 v57, v57, v25
    v_sub_f32 v74, v74, v24
    v_sub_f32 v42, v42, v24
    v_mul_f32 v58, v58, v25
    v_sub_f32 v75, v75, v24
    v_sub_f32 v43, v43, v24
    v_mul_f32 v59, v59, v25
    v_sub_f32 v76, v76, v24
    v_sub_f32 v44, v44, v24
    v_mul_f32 v60, v60, v25
    v_sub_f32 v77, v77, v24
    v_sub_f32 v45, v45, v24
    v_mul_f32 v61, v61, v25
    v_sub_f32 v78, v78, v24
    v_sub_f32 v46, v46, v24
    v_mul_f32 v62, v62, v25
    v_sub_f32 v79, v79, v24
    v_sub_f32 v47, v47, v24
    v_mul_f32 v63, v63, v25
    v_lshlrev_b32 v26, 16, v8
    v_and_b32 v27, 0xffff0000, v8
    v_mul_f32 v26, v26, v25
    v_mul_f32 v27, v27, v25
    v_cvt_pk_bf16_f32 v8, v26, v27
    v_lshlrev_b32 v26, 16, v9
    v_and_b32 v27, 0xffff0000, v9
    v_mul_f32 v26, v26, v25
    v_mul_f32 v27, v27, v25
    v_cvt_pk_bf16_f32 v9, v26, v27
    v_lshlrev_b32 v26, 16, v10
    v_and_b32 v27, 0xffff0000, v10
    v_mul_f32 v26, v26, v25
    v_mul_f32 v27, v27, v25
    v_cvt_pk_bf16_f32 v10, v26, v27
    v_lshlrev_b32 v26, 16, v11
    v_and_b32 v27, 0xffff0000, v11
    v_mul_f32 v26, v26, v25
    v_mul_f32 v27, v27, v25
    v_cvt_pk_bf16_f32 v11, v26, v27
    v_lshlrev_b32 v26, 16, v12
    v_and_b32 v27, 0xffff0000, v12
    v_mul_f32 v26, v26, v25
    v_mul_f32 v27, v27, v25
    v_cvt_pk_bf16_f32 v12, v26, v27
    v_lshlrev_b32 v26, 16, v13
    v_and_b32 v27, 0xffff0000, v13
    v_mul_f32 v26, v26, v25
    v_mul_f32 v27, v27, v25
    v_cvt_pk_bf16_f32 v13, v26, v27
    v_lshlrev_b32 v26, 16, v14
    v_and_b32 v27, 0xffff0000, v14
    v_mul_f32 v26, v26, v25
    v_mul_f32 v27, v27, v25
    v_cvt_pk_bf16_f32 v14, v26, v27
    v_lshlrev_b32 v26, 16, v15
    v_and_b32 v27, 0xffff0000, v15
    v_mul_f32 v26, v26, v25
    v_mul_f32 v27, v27, v25
    v_cvt_pk_bf16_f32 v15, v26, v27
    s_nop 1
    s_branch at_backF0
at_rareC1:
    s_nop 15
    v_mov_b32 v25, v24
    s_nop 1
    v_permlane32_swap_b32 v24, v25
    s_nop 1
    v_max_f32 v24, v24, v25
    v_add_f32 v24, 0x42800000, v24
    v_max_f32 v24, 0, v24
    v_sub_f32 v25, 0, v24
    v_exp_f32 v25, v25
    v_sub_f32 v64, v64, v24
    v_sub_f32 v80, v80, v24
    v_sub_f32 v32, v32, v24
    v_mul_f32 v48, v48, v25
    v_sub_f32 v65, v65, v24
    v_sub_f32 v81, v81, v24
    v_sub_f32 v33, v33, v24
    v_mul_f32 v49, v49, v25
    v_sub_f32 v66, v66, v24
    v_sub_f32 v82, v82, v24
    v_sub_f32 v34, v34, v24
    v_mul_f32 v50, v50, v25
    v_sub_f32 v67, v67, v24
    v_sub_f32 v83, v83, v24
    v_sub_f32 v35, v35, v24
    v_mul_f32 v51, v51, v25
    v_sub_f32 v68, v68, v24
    v_sub_f32 v84, v84, v24
    v_sub_f32 v36, v36, v24
    v_mul_f32 v52, v52, v25
    v_sub_f32 v69, v69, v24
    v_sub_f32 v85, v85, v24
    v_sub_f32 v37, v37, v24
    v_mul_f32 v53, v53, v25
    v_sub_f32 v70, v70, v24
    v_sub_f32 v86, v86, v24
    v_sub_f32 v38, v38, v24
    v_mul_f32 v54, v54, v25
    v_sub_f32 v71, v71, v24
    v_sub_f32 v87, v87, v24
    v_sub_f32 v39, v39, v24
    v_mul_f32 v55, v55, v25
    v_sub_f32 v72, v72, v24
    v_sub_f32 v88, v88, v24
    v_sub_f32 v40, v40, v24
    v_mul_f32 v56, v56, v25
    v_sub_f32 v73, v73, v24
    v_sub_f32 v89, v89, v24
    v_sub_f32 v41, v41, v24
    v_mul_f32 v57, v57, v25
    v_sub_f32 v74, v74, v24
    v_sub_f32 v90, v90, v24
    v_sub_f32 v42, v42, v24
    v_mul_f32 v58, v58, v25
    v_sub_f32 v75, v75, v24
    v_sub_f32 v91, v91, v24
    v_sub_f32 v43, v43, v24
    v_mul_f32 v59, v59, v25
    v_sub_f32 v76, v76, v24
    v_sub_f32 v92, v92, v24
    v_sub_f32 v44, v44, v24
    v_mul_f32 v60, v60, v25
    v_sub_f32 v77, v77, v24
    v_sub_f32 v93, v93, v24
    v_sub_f32 v45, v45, v24
    v_mul_f32 v61, v61, v25
    v_sub_f32 v78, v78, v24
    v_sub_f32 v94, v94, v24
    v_sub_f32 v46, v46, v24
    v_mul_f32 v62, v62, v25
    v_sub_f32 v79, v79, v24
    v_sub_f32 v95, v95, v24
    v_sub_f32 v47, v47, v24
    v_mul_f32 v63, v63, v25
    s_nop 1
    s_branch at_backC1
at_rareF1:
    s_nop 15
    v_mov_b32 v24, v58
    v_mov_b32 v25, v58
    s_nop 1
    v_permlane32_swap_b32 v24, v25
    s_nop 1
    v_log_f32 v24, v24
    s_nop 0
    v_floor_f32 v24, v24
    v_add_f32 v24, 0x42800000, v24
    v_max_f32 v24, 0, v24
    v_min_f32 v24, 0x42f00000, v24
    v_sub_f32 v25, 0, v24
    v_exp_f32 v25, v25
    v_sub_f32 v80, v80, v24
    v_sub_f32 v32, v32, v24
    v_mul_f32 v48, v48, v25
    v_sub_f32 v81, v81, v24
    v_sub_f32 v33, v33, v24
    v_mul_f32 v49, v49, v25
    v_sub_f32 v82, v82, v24
    v_sub_f32 v34, v34, v24
    v_mul_f32 v50, v50, v25
    v_sub_f32 v83, v83, v24
    v_sub_f32 v35, v35, v24
    v_mul_f32 v51, v51, v25
    v_sub_f32 v84, v84, v24
    v_sub_f32 v36, v36, v24
    v_mul_f32 v52, v52, v25
    v_sub_f32 v85, v85, v24
    v_sub_f32 v37, v37, v24
    v_mul_f32 v53, v53, v25
    v_sub_f32 v86, v86, v24
    v_sub_f32 v38, v38, v24
    v_mul_f32 v54, v54, v25
    v_sub_f32 v87, v87, v24
    v_sub_f32 v39, v39, v24
    v_mul_f32 v55, v55, v25
    v_sub_f32 v88, v88, v24
    v_sub_f32 v40, v40, v24
    v_mul_f32 v56, v56, v25
    v_sub_f32 v89, v89, v24
    v_sub_f32 v41, v41, v24
    v_mul_f32 v57, v57, v25
    v_sub_f32 v90, v90, v24
    v_sub_f32 v42, v42, v24
    v_mul_f32 v58, v58, v25
    v_sub_f32 v91, v91, v24
    v_sub_f32 v43, v43, v24
    v_mul_f32 v59, v59, v25
    v_sub_f32 v92, v92, v24
    v_sub_f32 v44, v44, v24
    v_mul_f32 v60, v60, v25
    v_sub_f32 v93, v93, v24
    v_sub_f32 v45, v45, v24
    v_mul_f32 v61, v61, v25
    v_sub_f32 v94, v94, v24
    v_sub_f32 v46, v46, v24
    v_mul_f32 v62, v62, v25
    v_sub_f32 v95, v95, v24
    v_sub_f32 v47, v47, v24
    v_mul_f32 v63, v63, v25
    v_lshlrev_b32 v26, 16, v96
    v_and_b32 v27, 0xffff0000, v96
    v_mul_f32 v26, v26, v25
    v_mul_f32 v27, v27, v25
    v_cvt_pk_bf16_f32 v96, v26, v27
    v_lshlrev_b32 v26, 16, v97
    v_and_b32 v27, 0xffff0000, v97
    v_mul_f32 v26, v26, v25
    v_mul_f32 v27, v27, v25
    v_cvt_pk_bf16_f32 v97, v26, v27
    v_lshlrev_b32 v26, 16, v98
    v_and_b32 v27, 0xffff0000, v98
    v_mul_f32 v26, v26, v25
    v_mul_f32 v27, v27, v25
    v_cvt_pk_bf16_f32 v98, v26, v27
    v_lshlrev_b32 v26, 16, v99
    v_and_b32 v27, 0xffff0000, v99
    v_mul_f32 v26, v26, v25
    v_mul_f32 v27, v27, v25
    v_cvt_pk_bf16_f32 v99, v26, v27
    v_lshlrev_b32 v26, 16, v100
    v_and_b32 v27, 0xffff0000, v100
    v_mul_f32 v26, v26, v25
    v_mul_f32 v27, v27, v25
    v_cvt_pk_bf16_f32 v100, v26, v27
    v_lshlrev_b32 v26, 16, v101
    v_and_b32 v27, 0xffff0000, v101
    v_mul_f32 v26, v26, v25
    v_mul_f32 v27, v27, v25
    v_cvt_pk_bf16_f32 v101, v26, v27
    v_lshlrev_b32 v26, 16, v102
    v_and_b32 v27, 0xffff0000, v102
    v_mul_f32 v26, v26, v25
    v_mul_f32 v27, v27, v25
    v_cvt_pk_bf16_f32 v102, v26, v27
    v_lshlrev_b32 v26, 16, v103
    v_and_b32 v27, 0xffff0000, v103
    v_mul_f32 v26, v26, v25
    v_mul_f32 v27, v27, v25
    v_cvt_pk_bf16_f32 v103, v26, v27
    s_nop 1
    s_branch at_backF1
at_done:
    s_endpgm
.section .rodata,"a"
.p2align 6
.amdhsa_kernel attn_kernel
  .amdhsa_next_free_vgpr 128
  .amdhsa_next_free_sgpr 72
  .amdhsa_accum_offset 128
  .amdhsa_group_segment_fixed_size 0
  .amdhsa_kernarg_size 104
  .amdhsa_user_sgpr_count 2
  .amdhsa_user_sgpr_kernarg_segment_ptr 1
  .amdhsa_system_sgpr_workgroup_id_x 1
.end_amdhsa_kernel
.text
.globl gemm2_kernel
.p2align 8
.type gemm2_kernel,@function
gemm2_kernel:
    s_load_dwordx2 s[4:5], s[0:1], 56
    s_load_dwordx2 s[6:7], s[0:1], 64
    s_load_dwordx2 s[10:11], s[0:1], 96
    s_load_dwordx2 s[48:49], s[0:1], 32
    s_load_dwordx2 s[50:51], s[0:1], 72
    s_cmp_ge_u32 s2, 256
    s_cbranch_scc1 g2_done
    s_and_b32 s36, s2, 7
    s_lshr_b32 s37, s2, 3
    s_and_b32 s38, s36, 3
    s_lshl_b32 s38, s38, 2
    s_and_b32 s28, s37, 3
    s_add_u32 s28, s28, s38
    s_lshr_b32 s38, s36, 2
    s_lshl_b32 s38, s38, 3
    s_lshr_b32 s29, s37, 2
    s_add_u32 s29, s29, s38
    s_waitcnt lgkmcnt(0)

    s_mov_b32 s12, s4
    s_and_b32 s13, s5, 0xffff
    s_mov_b32 s14, 0x800000
    s_mov_b32 s15, 0x00020000
    s_mul_i32 s36, s29, 288
    s_mul_i32 s37, s29, 589824
    s_add_u32 s37, s37, 36700160
    s_add_u32 s16, s10, s37
    s_addc_u32 s17, s11, 0
    s_and_b32 s17, s17, 0xffff
    s_mov_b32 s18, 0x90000
    s_mov_b32 s19, 0x00020000
    s_mov_b32 s31, 9216
    s_add_u32 s37, s36, 24118400
    s_sub_u32 s38, 35913728, s37
    s_add_u32 s20, s10, s37
    s_addc_u32 s21, s11, 0
    s_and_b32 s21, s21, 0xffff
    s_mov_b32 s22, s38
    s_mov_b32 s23, 0x00020000
    s_add_u32 s37, s36, 5242880
    s_sub_u32 s38, 24117248, s37
    s_add_u32 s24, s10, s37
    s_addc_u32 s25, s11, 0
    s_and_b32 s25, s25, 0xffff
    s_mov_b32 s26, s38
    s_mov_b32 s27, 0x00020000
    s_mov_b32 s44, s6
    s_and_b32 s45, s7, 0xffff
    s_mov_b32 s46, 0x1000
    s_mov_b32 s47, 0x00020000
    v_lshrrev_b32 v1, 6, v0
    s_nop 0
    v_readfirstlane_b32 s30, v1
    v_and_b32 v1, 63, v0
    s_cmp_ge_u32 s30, 4
    s_cbranch_scc1 g2_loader
    v_and_b32 v6, 15, v1
    v_lshrrev_b32 v7, 4, v1

    v_lshrrev_b32 v2, 2, v1
    v_mul_u32_u24 v2, 288, v2
    v_and_b32 v3, 3, v1
    v_lshl_add_u32 v2, v3, 3, v2

    v_add_u32 v128, 65536, v2
    v_mov_b32 v129, v128
    s_lshl_b32 s36, s30, 12
    v_add_u32 v3, 0, v7
    v_and_b32 v2, 7, v6
    v_xor_b32 v3, v3, v2
    v_lshlrev_b32 v3, 4, v3
    v_lshl_add_u32 v3, v6, 7, v3
    v_add_u32 v130, s36, v3
    v_add_u32 v3, 4, v7
    v_and_b32 v2, 7, v6
    v_xor_b32 v3, v3, v2
    v_lshlrev_b32 v3, 4, v3
    v_lshl_add_u32 v3, v6, 7, v3
    v_add_u32 v131, s36, v3
    s_mul_i32 s36, s28, 128
    s_lshl_b32 s37, s30, 5
    s_add_u32 s36, s36, s37
    v_add_u32 v6, s36, v6

    v_mov_b32 v16, 0
    v_mov_b32 v17, 0
    v_mov_b32 v18, 0
    v_mov_b32 v19, 0
    v_mov_b32 v20, 0
    v_mov_b32 v21, 0
    v_mov_b32 v22, 0
    v_mov_b32 v23, 0
    v_mov_b32 v24, 0
    v_mov_b32 v25, 0
    v_mov_b32 v26, 0
    v_mov_b32 v27, 0
    v_mov_b32 v28, 0
    v_mov_b32 v29, 0
    v_mov_b32 v30, 0
    v_mov_b32 v31, 0
    v_mov_b32 v32, 0
    v_mov_b32 v33, 0
    v_mov_b32 v34, 0
    v_mov_b32 v35, 0
    v_mov_b32 v36, 0
    v_mov_b32 v37, 0
    v_mov_b32 v38, 0
    v_mov_b32 v39, 0
    v_mov_b32 v40, 0
    v_mov_b32 v41, 0
    v_mov_b32 v42, 0
    v_mov_b32 v43, 0
    v_mov_b32 v44, 0
    v_mov_b32 v45, 0
    v_mov_b32 v46, 0
    v_mov_b32 v47, 0
    v_mov_b32 v48, 0
    v_mov_b32 v49, 0
    v_mov_b32 v50, 0
    v_mov_b32 v51, 0
    v_mov_b32 v52, 0
    v_mov_b32 v53, 0
    v_mov_b32 v54, 0
    v_mov_b32 v55, 0
    v_mov_b32 v56, 0
    v_mov_b32 v57, 0
    v_mov_b32 v58, 0
    v_mov_b32 v59, 0
    v_mov_b32 v60, 0
    v_mov_b32 v61, 0
    v_mov_b32 v62, 0
    v_mov_b32 v63, 0
    v_mov_b32 v64, 0
    v_mov_b32 v65, 0
    v_mov_b32 v66, 0
    v_mov_b32 v67, 0
    v_mov_b32 v68, 0
    v_mov_b32 v69, 0
    v_mov_b32 v70, 0
    v_mov_b32 v71, 0
    v_mov_b32 v72, 0
    v_mov_b32 v73, 0
    v_mov_b32 v74, 0
    v_mov_b32 v75, 0
    v_mov_b32 v76, 0
    v_mov_b32 v77, 0
    v_mov_b32 v78, 0
    v_mov_b32 v79, 0
    v_mov_b32 v80, 0
    v_mov_b32 v81, 0
    v_mov_b32 v82, 0
    v_mov_b32 v83, 0
    v_mov_b32 v84, 0
    v_mov_b32 v85, 0
    v_mov_b32 v86, 0
    v_mov_b32 v87, 0
    s_lshl_b32 s36, s28, 7
    s_lshl_b32 s37, s30, 5
    s_add_u32 s36, s36, s37
    s_mul_i32 s40, s36, 9216
    s_mul_i32 s41, s36, 5760
    s_mov_b32 s32, 0
    s_mov_b32 s33, 0
    s_mov_b32 s34, 0
    s_mov_b32 s35, 0
    s_mov_b32 s39, 32
    s_barrier
    ds_read_b128 v[88:91], v130 offset:0
    ds_read_b128 v[92:95], v130 offset:2048
    ds_read_b64_tr_b16 v[104:105], v128 offset:0
    ds_read_b64_tr_b16 v[106:107], v128 offset:4608
    ds_read_b64_tr_b16 v[108:109], v128 offset:32
    ds_read_b64_tr_b16 v[110:111], v128 offset:4640
    ds_read_b64_tr_b16 v[112:113], v128 offset:64
    ds_read_b64_tr_b16 v[114:115], v128 offset:4672
    ds_read_b64_tr_b16 v[116:117], v128 offset:96
    ds_read_b64_tr_b16 v[118:119], v128 offset:4704
    ds_read_b64_tr_b16 v[120:121], v128 offset:128
    ds_read_b64_tr_b16 v[122:123], v128 offset:4736
g2_loop:
    s_waitcnt lgkmcnt(10)
    s_waitcnt lgkmcnt(8)
    v_mfma_f32_16x16x32_bf16 v[16:19], v[104:107], v[88:91], v[16:19]
    ds_read_b64_tr_b16 v[124:125], v128 offset:160
    ds_read_b64_tr_b16 v[126:127], v128 offset:4768
    v_mfma_f32_16x16x32_bf16 v[52:55], v[104:107], v[92:95], v[52:55]
    s_waitcnt lgkmcnt(8)
    v_mfma_f32_16x16x32_bf16 v[20:23], v[108:111], v[88:91], v[20:23]
    ds_read_b64_tr_b16 v[104:105], v128 offset:192
    ds_read_b64_tr_b16 v[106:107], v128 offset:4800
    v_mfma_f32_16x16x32_bf16 v[56:59], v[108:111], v[92:95], v[56:59]
    s_waitcnt lgkmcnt(8)
    v_mfma_f32_16x16x32_bf16 v[24:27], v[112:115], v[88:91], v[24:27]
    ds_read_b64_tr_b16 v[108:109], v128 offset:224
    ds_read_b64_tr_b16 v[110:111], v128 offset:4832
    v_mfma_f32_16x16x32_bf16 v[60:63], v[112:115], v[92:95], v[60:63]
    s_waitcnt lgkmcnt(8)
    v_mfma_f32_16x16x32_bf16 v[28:31], v[116:119], v[88:91], v[28:31]
    ds_read_b64_tr_b16 v[112:113], v128 offset:256
    ds_read_b64_tr_b16 v[114:115], v128 offset:4864
    v_mfma_f32_16x16x32_bf16 v[64:67], v[116:119], v[92:95], v[64:67]
    s_add_u32 s34, s34, 9216
    s_cmp_eq_u32 s34, 73728
    s_cselect_b32 s34, 0, s34
    s_sub_u32 s36, s34, s33
    s_mov_b32 s33, s34
    v_add_u32 v129, s36, v129
    ds_read_b128 v[96:99], v131 offset:0
    ds_read_b128 v[100:103], v131 offset:2048
    s_waitcnt lgkmcnt(10)
    v_mfma_f32_16x16x32_bf16 v[32:35], v[120:123], v[88:91], v[32:35]
    ds_read_b64_tr_b16 v[116:117], v129 offset:0
    ds_read_b64_tr_b16 v[118:119], v129 offset:4608
    v_mfma_f32_16x16x32_bf16 v[68:71], v[120:123], v[92:95], v[68:71]
    s_waitcnt lgkmcnt(10)
    v_mfma_f32_16x16x32_bf16 v[36:39], v[124:127], v[88:91], v[36:39]
    ds_read_b64_tr_b16 v[120:121], v129 offset:32
    ds_read_b64_tr_b16 v[122:123], v129 offset:4640
    v_mfma_f32_16x16x32_bf16 v[72:75], v[124:127], v[92:95], v[72:75]
    s_waitcnt lgkmcnt(10)
    v_mfma_f32_16x16x32_bf16 v[40:43], v[104:107], v[88:91], v[40:43]
    ds_read_b64_tr_b16 v[124:125], v129 offset:64
    ds_read_b64_tr_b16 v[126:127], v129 offset:4672
    v_mfma_f32_16x16x32_bf16 v[76:79], v[104:107], v[92:95], v[76:79]
    s_waitcnt lgkmcnt(10)
    v_mfma_f32_16x16x32_bf16 v[44:47], v[108:111], v[88:91], v[44:47]
    ds_read_b64_tr_b16 v[104:105], v129 offset:96
    ds_read_b64_tr_b16 v[106:107], v129 offset:4704
    v_mfma_f32_16x16x32_bf16 v[80:83], v[108:111], v[92:95], v[80:83]
    s_waitcnt lgkmcnt(10)
    v_mfma_f32_16x16x32_bf16 v[48:51], v[112:115], v[88:91], v[48:51]
    ds_read_b64_tr_b16 v[108:109], v129 offset:128
    ds_read_b64_tr_b16 v[110:111], v129 offset:4736
    v_mfma_f32_16x16x32_bf16 v[84:87], v[112:115], v[92:95], v[84:87]
    s_waitcnt lgkmcnt(10)
    s_waitcnt lgkmcnt(8)
    v_mfma_f32_16x16x32_bf16 v[16:19], v[116:119], v[96:99], v[16:19]
    ds_read_b64_tr_b16 v[112:113], v129 offset:160
    ds_read_b64_tr_b16 v[114:115], v129 offset:4768
    v_mfma_f32_16x16x32_bf16 v[52:55], v[116:119], v[100:103], v[52:55]
    s_waitcnt lgkmcnt(8)
    v_mfma_f32_16x16x32_bf16 v[20:23], v[120:123], v[96:99], v[20:23]
    ds_read_b64_tr_b16 v[116:117], v129 offset:192
    ds_read_b64_tr_b16 v[118:119], v129 offset:4800
    v_mfma_f32_16x16x32_bf16 v[56:59], v[120:123], v[100:103], v[56:59]
    s_waitcnt lgkmcnt(8)
    v_mfma_f32_16x16x32_bf16 v[24:27], v[124:127], v[96:99], v[24:27]
    ds_read_b64_tr_b16 v[120:121], v129 offset:224
    ds_read_b64_tr_b16 v[122:123], v129 offset:4832
    v_mfma_f32_16x16x32_bf16 v[60:63], v[124:127], v[100:103], v[60:63]
    s_waitcnt lgkmcnt(8)
    v_mfma_f32_16x16x32_bf16 v[28:31], v[104:107], v[96:99], v[28:31]
    ds_read_b64_tr_b16 v[124:125], v129 offset:256
    ds_read_b64_tr_b16 v[126:127], v129 offset:4864
    v_mfma_f32_16x16x32_bf16 v[64:67], v[104:107], v[100:103], v[64:67]
    s_add_u32 s34, s34, 9216
    s_cmp_eq_u32 s34, 73728
    s_cselect_b32 s34, 0, s34
    s_sub_u32 s36, s34, s32
    s_mov_b32 s32, s34
    v_add_u32 v128, s36, v128
    s_add_u32 s37, s35, 16384
    s_cmp_eq_u32 s37, 65536
    s_cselect_b32 s37, 0, s37
    s_sub_u32 s36, s37, s35
    s_mov_b32 s35, s37
    v_add_u32 v130, s36, v130
    s_mov_b32 s38, s36
    s_barrier
    ds_read_b128 v[88:91], v130 offset:0
    ds_read_b128 v[92:95], v130 offset:2048
    v_add_u32 v131, s38, v131
    s_waitcnt lgkmcnt(10)
    v_mfma_f32_16x16x32_bf16 v[32:35], v[108:111], v[96:99], v[32:35]
    ds_read_b64_tr_b16 v[104:105], v128 offset:0
    ds_read_b64_tr_b16 v[106:107], v128 offset:4608
    v_mfma_f32_16x16x32_bf16 v[68:71], v[108:111], v[100:103], v[68:71]
    s_waitcnt lgkmcnt(10)
    v_mfma_f32_16x16x32_bf16 v[36:39], v[112:115], v[96:99], v[36:39]
    ds_read_b64_tr_b16 v[108:109], v128 offset:32
    ds_read_b64_tr_b16 v[110:111], v128 offset:4640
    v_mfma_f32_16x16x32_bf16 v[72:75], v[112:115], v[100:103], v[72:75]
    s_waitcnt lgkmcnt(10)
    v_mfma_f32_16x16x32_bf16 v[40:43], v[116:119], v[96:99], v[40:43]
    ds_read_b64_tr_b16 v[112:113], v128 offset:64
    ds_read_b64_tr_b16 v[114:115], v128 offset:4672
    v_mfma_f32_16x16x32_bf16 v[76:79], v[116:119], v[100:103], v[76:79]
    s_waitcnt lgkmcnt(10)
    v_mfma_f32_16x16x32_bf16 v[44:47], v[120:123], v[96:99], v[44:47]
    ds_read_b64_tr_b16 v[116:117], v128 offset:96
    ds_read_b64_tr_b16 v[118:119], v128 offset:4704
    v_mfma_f32_16x16x32_bf16 v[80:83], v[120:123], v[100:103], v[80:83]
    s_waitcnt lgkmcnt(10)
    v_mfma_f32_16x16x32_bf16 v[48:51], v[124:127], v[96:99], v[48:51]
    ds_read_b64_tr_b16 v[120:121], v128 offset:128
    ds_read_b64_tr_b16 v[122:123], v128 offset:4736
    v_mfma_f32_16x16x32_bf16 v[84:87], v[124:127], v[100:103], v[84:87]
    s_sub_u32 s39, s39, 1
    s_cmp_eq_u32 s39, 6
    s_cbranch_scc1 g2_late
g2_lateback:
    s_cmp_lg_u32 s39, 0
    s_cbranch_scc1 g2_loop
    s_waitcnt lgkmcnt(0)
    s_nop 7
    s_nop 7
    s_barrier
    s_waitcnt vmcnt(0)
    v_lshlrev_b32 v4, 16, v4
    v_lshlrev_b32 v5, 16, v5
    s_mul_i32 s42, s30, 18944
    v_and_b32 v2, 15, v1
    v_mul_u32_u24 v2, 592, v2
    v_lshl_add_u32 v2, v7, 4, v2
    v_add_u32 v2, s42, v2

    v_add_f32 v16, v16, v4
    v_add_f32 v17, v17, v4
    v_add_f32 v18, v18, v4
    v_add_f32 v19, v19, v4
    ds_write_b128 v2, v[16:19] offset:0
    v_add_f32 v20, v20, v4
    v_add_f32 v21, v21, v4
    v_add_f32 v22, v22, v4
    v_add_f32 v23, v23, v4
    ds_write_b128 v2, v[20:23] offset:64
    v_add_f32 v24, v24, v4
    v_add_f32 v25, v25, v4
    v_add_f32 v26, v26, v4
    v_add_f32 v27, v27, v4
    ds_write_b128 v2, v[24:27] offset:128
    v_add_f32 v28, v28, v4
    v_add_f32 v29, v29, v4
    v_add_f32 v30, v30, v4
    v_add_f32 v31, v31, v4
    ds_write_b128 v2, v[28:31] offset:192
    v_add_f32 v32, v32, v4
    v_add_f32 v33, v33, v4
    v_add_f32 v34, v34, v4
    v_add_f32 v35, v35, v4
    ds_write_b128 v2, v[32:35] offset:256
    v_add_f32 v36, v36, v4
    v_add_f32 v37, v37, v4
    v_add_f32 v38, v38, v4
    v_add_f32 v39, v39, v4
    ds_write_b128 v2, v[36:39] offset:320
    v_add_f32 v40, v40, v4
    v_add_f32 v41, v41, v4
    v_add_f32 v42, v42, v4
    v_add_f32 v43, v43, v4
    ds_write_b128 v2, v[40:43] offset:384
    v_add_f32 v44, v44, v4
    v_add_f32 v45, v45, v4
    v_add_f32 v46, v46, v4
    v_add_f32 v47, v47, v4
    ds_write_b128 v2, v[44:47] offset:448
    v_add_f32 v48, v48, v4
    v_add_f32 v49, v49, v4
    v_add_f32 v50, v50, v4
    v_add_f32 v51, v51, v4
    ds_write_b128 v2, v[48:51] offset:512
    v_add_f32 v52, v52, v5
    v_add_f32 v53, v53, v5
    v_add_f32 v54, v54, v5
    v_add_f32 v55, v55, v5
    ds_write_b128 v2, v[52:55] offset:9472
    v_add_f32 v56, v56, v5
    v_add_f32 v57, v57, v5
    v_add_f32 v58, v58, v5
    v_add_f32 v59, v59, v5
    ds_write_b128 v2, v[56:59] offset:9536
    v_add_f32 v60, v60, v5
    v_add_f32 v61, v61, v5
    v_add_f32 v62, v62, v5
    v_add_f32 v63, v63, v5
    ds_write_b128 v2, v[60:63] offset:9600
    v_add_f32 v64, v64, v5
    v_add_f32 v65, v65, v5
    v_add_f32 v66, v66, v5
    v_add_f32 v67, v67, v5
    ds_write_b128 v2, v[64:67] offset:9664
    v_add_f32 v68, v68, v5
    v_add_f32 v69, v69, v5
    v_add_f32 v70, v70, v5
    v_add_f32 v71, v71, v5
    ds_write_b128 v2, v[68:71] offset:9728
    v_add_f32 v72, v72, v5
    v_add_f32 v73, v73, v5
    v_add_f32 v74, v74, v5
    v_add_f32 v75, v75, v5
    ds_write_b128 v2, v[72:75] offset:9792
    v_add_f32 v76, v76, v5
    v_add_f32 v77, v77, v5
    v_add_f32 v78, v78, v5
    v_add_f32 v79, v79, v5
    ds_write_b128 v2, v[76:79] offset:9856
    v_add_f32 v80, v80, v5
    v_add_f32 v81, v81, v5
    v_add_f32 v82, v82, v5
    v_add_f32 v83, v83, v5
    ds_write_b128 v2, v[80:83] offset:9920
    v_add_f32 v84, v84, v5
    v_add_f32 v85, v85, v5
    v_add_f32 v86, v86, v5
    v_add_f32 v87, v87, v5
    ds_write_b128 v2, v[84:87] offset:9984
    v_add_u32 v5, 0, v1
    v_mul_u32_u24 v3, 3641, v5
    v_lshrrev_b32 v3, 16, v3
    v_mul_u32_u24 v4, 18, v3
    v_sub_u32 v4, v5, v4
    v_mul_u32_u24 v5, 592, v3
    v_lshl_add_u32 v5, v4, 5, v5
    v_add_u32 v120, s42, v5
    v_mul_u32_u24 v5, 5760, v3
    v_lshl_add_u32 v104, v4, 4, v5
    v_add_u32 v5, 64, v1
    v_mul_u32_u24 v3, 3641, v5
    v_lshrrev_b32 v3, 16, v3
    v_mul_u32_u24 v4, 18, v3
    v_sub_u32 v4, v5, v4
    v_mul_u32_u24 v5, 592, v3
    v_lshl_add_u32 v5, v4, 5, v5
    v_add_u32 v121, s42, v5
    v_mul_u32_u24 v5, 5760, v3
    v_lshl_add_u32 v105, v4, 4, v5
    v_add_u32 v5, 128, v1
    v_mul_u32_u24 v3, 3641, v5
    v_lshrrev_b32 v3, 16, v3
    v_mul_u32_u24 v4, 18, v3
    v_sub_u32 v4, v5, v4
    v_mul_u32_u24 v5, 592, v3
    v_lshl_add_u32 v5, v4, 5, v5
    v_add_u32 v122, s42, v5
    v_mul_u32_u24 v5, 5760, v3
    v_lshl_add_u32 v106, v4, 4, v5
    v_add_u32 v5, 192, v1
    v_mul_u32_u24 v3, 3641, v5
    v_lshrrev_b32 v3, 16, v3
    v_mul_u32_u24 v4, 18, v3
    v_sub_u32 v4, v5, v4
    v_mul_u32_u24 v5, 592, v3
    v_lshl_add_u32 v5, v4, 5, v5
    v_add_u32 v123, s42, v5
    v_mul_u32_u24 v5, 5760, v3
    v_lshl_add_u32 v107, v4, 4, v5
    v_add_u32 v5, 256, v1
    v_mul_u32_u24 v3, 3641, v5
    v_lshrrev_b32 v3, 16, v3
    v_mul_u32_u24 v4, 18, v3
    v_sub_u32 v4, v5, v4
    v_mul_u32_u24 v5, 592, v3
    v_lshl_add_u32 v5, v4, 5, v5
    v_add_u32 v124, s42, v5
    v_mul_u32_u24 v5, 5760, v3
    v_lshl_add_u32 v108, v4, 4, v5
    v_add_u32 v5, 320, v1
    v_mul_u32_u24 v3, 3641, v5
    v_lshrrev_b32 v3, 16, v3
    v_mul_u32_u24 v4, 18, v3
    v_sub_u32 v4, v5, v4
    v_mul_u32_u24 v5, 592, v3
    v_lshl_add_u32 v5, v4, 5, v5
    v_add_u32 v125, s42, v5
    v_mul_u32_u24 v5, 5760, v3
    v_lshl_add_u32 v109, v4, 4, v5
    v_add_u32 v5, 384, v1
    v_mul_u32_u24 v3, 3641, v5
    v_lshrrev_b32 v3, 16, v3
    v_mul_u32_u24 v4, 18, v3
    v_sub_u32 v4, v5, v4
    v_mul_u32_u24 v5, 592, v3
    v_lshl_add_u32 v5, v4, 5, v5
    v_add_u32 v126, s42, v5
    v_mul_u32_u24 v5, 5760, v3
    v_lshl_add_u32 v110, v4, 4, v5
    v_add_u32 v5, 448, v1
    v_mul_u32_u24 v3, 3641, v5
    v_lshrrev_b32 v3, 16, v3
    v_mul_u32_u24 v4, 18, v3
    v_sub_u32 v4, v5, v4
    v_mul_u32_u24 v5, 592, v3
    v_lshl_add_u32 v5, v4, 5, v5
    v_add_u32 v127, s42, v5
    v_mul_u32_u24 v5, 5760, v3
    v_lshl_add_u32 v111, v4, 4, v5
    v_add_u32 v5, 512, v1
    v_mul_u32_u24 v3, 3641, v5
    v_lshrrev_b32 v3, 16, v3
    v_mul_u32_u24 v4, 18, v3
    v_sub_u32 v4, v5, v4
    v_mul_u32_u24 v5, 592, v3
    v_lshl_add_u32 v5, v4, 5, v5
    v_add_u32 v128, s42, v5
    v_mul_u32_u24 v5, 5760, v3
    v_lshl_add_u32 v112, v4, 4, v5
    s_waitcnt lgkmcnt(0)
    ds_read_b128 v[16:19], v120
    ds_read_b128 v[20:23], v120 offset:16
    ds_read_b128 v[24:27], v121
    ds_read_b128 v[28:31], v121 offset:16
    ds_read_b128 v[32:35], v122
    ds_read_b128 v[36:39], v122 offset:16
    ds_read_b128 v[40:43], v123
    ds_read_b128 v[44:47], v123 offset:16
    ds_read_b128 v[48:51], v124
    ds_read_b128 v[52:55], v124 offset:16
    ds_read_b128 v[56:59], v125
    ds_read_b128 v[60:63], v125 offset:16
    ds_read_b128 v[64:67], v126
    ds_read_b128 v[68:71], v126 offset:16
    ds_read_b128 v[72:75], v127
    ds_read_b128 v[76:79], v127 offset:16
    ds_read_b128 v[80:83], v128
    ds_read_b128 v[84:87], v128 offset:16
    s_waitcnt lgkmcnt(15)
    v_lshlrev_b32 v88, 16, v144
    v_and_b32 v89, 0xffff0000, v144
    v_lshlrev_b32 v90, 16, v145
    v_and_b32 v91, 0xffff0000, v145
    v_lshlrev_b32 v92, 16, v146
    v_and_b32 v93, 0xffff0000, v146
    v_lshlrev_b32 v94, 16, v147
    v_and_b32 v95, 0xffff0000, v147
    v_mul_f32 v88, v88, v16
    v_mul_f32 v89, v89, v17
    v_mul_f32 v90, v90, v18
    v_mul_f32 v91, v91, v19
    v_mul_f32 v92, v92, v20
    v_mul_f32 v93, v93, v21
    v_mul_f32 v94, v94, v22
    v_mul_f32 v95, v95, v23
    v_cvt_pk_bf16_f32 v144, v88, v89
    v_cvt_pk_bf16_f32 v145, v90, v91
    v_cvt_pk_bf16_f32 v146, v92, v93
    v_cvt_pk_bf16_f32 v147, v94, v95
    buffer_store_dwordx4 v[144:147], v104, s[20:23], s41 offen
    s_waitcnt lgkmcnt(14)
    v_lshlrev_b32 v96, 16, v148
    v_and_b32 v97, 0xffff0000, v148
    v_lshlrev_b32 v98, 16, v149
    v_and_b32 v99, 0xffff0000, v149
    v_lshlrev_b32 v100, 16, v150
    v_and_b32 v101, 0xffff0000, v150
    v_lshlrev_b32 v102, 16, v151
    v_and_b32 v103, 0xffff0000, v151
    v_mul_f32 v96, v96, v24
    v_mul_f32 v97, v97, v25
    v_mul_f32 v98, v98, v26
    v_mul_f32 v99, v99, v27
    v_mul_f32 v100, v100, v28
    v_mul_f32 v101, v101, v29
    v_mul_f32 v102, v102, v30
    v_mul_f32 v103, v103, v31
    v_cvt_pk_bf16_f32 v148, v96, v97
    v_cvt_pk_bf16_f32 v149, v98, v99
    v_cvt_pk_bf16_f32 v150, v100, v101
    v_cvt_pk_bf16_f32 v151, v102, v103
    buffer_store_dwordx4 v[148:151], v105, s[20:23], s41 offen
    s_waitcnt lgkmcnt(12)
    v_lshlrev_b32 v88, 16, v152
    v_and_b32 v89, 0xffff0000, v152
    v_lshlrev_b32 v90, 16, v153
    v_and_b32 v91, 0xffff0000, v153
    v_lshlrev_b32 v92, 16, v154
    v_and_b32 v93, 0xffff0000, v154
    v_lshlrev_b32 v94, 16, v155
    v_and_b32 v95, 0xffff0000, v155
    v_mul_f32 v88, v88, v32
    v_mul_f32 v89, v89, v33
    v_mul_f32 v90, v90, v34
    v_mul_f32 v91, v91, v35
    v_mul_f32 v92, v92, v36
    v_mul_f32 v93, v93, v37
    v_mul_f32 v94, v94, v38
    v_mul_f32 v95, v95, v39
    v_cvt_pk_bf16_f32 v152, v88, v89
    v_cvt_pk_bf16_f32 v153, v90, v91
    v_cvt_pk_bf16_f32 v154, v92, v93
    v_cvt_pk_bf16_f32 v155, v94, v95
    buffer_store_dwordx4 v[152:155], v106, s[20:23], s41 offen
    s_waitcnt lgkmcnt(10)
    v_lshlrev_b32 v96, 16, v156
    v_and_b32 v97, 0xffff0000, v156
    v_lshlrev_b32 v98, 16, v157
    v_and_b32 v99, 0xffff0000, v157
    v_lshlrev_b32 v100, 16, v158
    v_and_b32 v101, 0xffff0000, v158
    v_lshlrev_b32 v102, 16, v159
    v_and_b32 v103, 0xffff0000, v159
    v_mul_f32 v96, v96, v40
    v_mul_f32 v97, v97, v41
    v_mul_f32 v98, v98, v42
    v_mul_f32 v99, v99, v43
    v_mul_f32 v100, v100, v44
    v_mul_f32 v101, v101, v45
    v_mul_f32 v102, v102, v46
    v_mul_f32 v103, v103, v47
    v_cvt_pk_bf16_f32 v156, v96, v97
    v_cvt_pk_bf16_f32 v157, v98, v99
    v_cvt_pk_bf16_f32 v158, v100, v101
    v_cvt_pk_bf16_f32 v159, v102, v103
    buffer_store_dwordx4 v[156:159], v107, s[20:23], s41 offen
    s_waitcnt lgkmcnt(8)
    v_lshlrev_b32 v88, 16, v160
    v_and_b32 v89, 0xffff0000, v160
    v_lshlrev_b32 v90, 16, v161
    v_and_b32 v91, 0xffff0000, v161
    v_lshlrev_b32 v92, 16, v162
    v_and_b32 v93, 0xffff0000, v162
    v_lshlrev_b32 v94, 16, v163
    v_and_b32 v95, 0xffff0000, v163
    v_mul_f32 v88, v88, v48
    v_mul_f32 v89, v89, v49
    v_mul_f32 v90, v90, v50
    v_mul_f32 v91, v91, v51
    v_mul_f32 v92, v92, v52
    v_mul_f32 v93, v93, v53
    v_mul_f32 v94, v94, v54
    v_mul_f32 v95, v95, v55
    v_cvt_pk_bf16_f32 v160, v88, v89
    v_cvt_pk_bf16_f32 v161, v90, v91
    v_cvt_pk_bf16_f32 v162, v92, v93
    v_cvt_pk_bf16_f32 v163, v94, v95
    buffer_store_dwordx4 v[160:163], v108, s[20:23], s41 offen
    s_waitcnt lgkmcnt(6)
    v_lshlrev_b32 v96, 16, v164
    v_and_b32 v97, 0xffff0000, v164
    v_lshlrev_b32 v98, 16, v165
    v_and_b32 v99, 0xffff0000, v165
    v_lshlrev_b32 v100, 16, v166
    v_and_b32 v101, 0xffff0000, v166
    v_lshlrev_b32 v102, 16, v167
    v_and_b32 v103, 0xffff0000, v167
    v_mul_f32 v96, v96, v56
    v_mul_f32 v97, v97, v57
    v_mul_f32 v98, v98, v58
    v_mul_f32 v99, v99, v59
    v_mul_f32 v100, v100, v60
    v_mul_f32 v101, v101, v61
    v_mul_f32 v102, v102, v62
    v_mul_f32 v103, v103, v63
    v_cvt_pk_bf16_f32 v164, v96, v97
    v_cvt_pk_bf16_f32 v165, v98, v99
    v_cvt_pk_bf16_f32 v166, v100, v101
    v_cvt_pk_bf16_f32 v167, v102, v103
    buffer_store_dwordx4 v[164:167], v109, s[20:23], s41 offen
    s_waitcnt lgkmcnt(4)
    v_lshlrev_b32 v88, 16, v168
    v_and_b32 v89, 0xffff0000, v168
    v_lshlrev_b32 v90, 16, v169
    v_and_b32 v91, 0xffff0000, v169
    v_lshlrev_b32 v92, 16, v170
    v_and_b32 v93, 0xffff0000, v170
    v_lshlrev_b32 v94, 16, v171
    v_and_b32 v95, 0xffff0000, v171
    v_mul_f32 v88, v88, v64
    v_mul_f32 v89, v89, v65
    v_mul_f32 v90, v90, v66
    v_mul_f32 v91, v91, v67
    v_mul_f32 v92, v92, v68
    v_mul_f32 v93, v93, v69
    v_mul_f32 v94, v94, v70
    v_mul_f32 v95, v95, v71
    v_cvt_pk_bf16_f32 v168, v88, v89
    v_cvt_pk_bf16_f32 v169, v90, v91
    v_cvt_pk_bf16_f32 v170, v92, v93
    v_cvt_pk_bf16_f32 v171, v94, v95
    buffer_store_dwordx4 v[168:171], v110, s[20:23], s41 offen
    s_waitcnt lgkmcnt(2)
    v_lshlrev_b32 v96, 16, v172
    v_and_b32 v97, 0xffff0000, v172
    v_lshlrev_b32 v98, 16, v173
    v_and_b32 v99, 0xffff0000, v173
    v_lshlrev_b32 v100, 16, v174
    v_and_b32 v101, 0xffff0000, v174
    v_lshlrev_b32 v102, 16, v175
    v_and_b32 v103, 0xffff0000, v175
    v_mul_f32 v96, v96, v72
    v_mul_f32 v97, v97, v73
    v_mul_f32 v98, v98, v74
    v_mul_f32 v99, v99, v75
    v_mul_f32 v100, v100, v76
    v_mul_f32 v101, v101, v77
    v_mul_f32 v102, v102, v78
    v_mul_f32 v103, v103, v79
    v_cvt_pk_bf16_f32 v172, v96, v97
    v_cvt_pk_bf16_f32 v173, v98, v99
    v_cvt_pk_bf16_f32 v174, v100, v101
    v_cvt_pk_bf16_f32 v175, v102, v103
    buffer_store_dwordx4 v[172:175], v111, s[20:23], s41 offen
    s_waitcnt lgkmcnt(0)
    v_lshlrev_b32 v88, 16, v176
    v_and_b32 v89, 0xffff0000, v176
    v_lshlrev_b32 v90, 16, v177
    v_and_b32 v91, 0xffff0000, v177
    v_lshlrev_b32 v92, 16, v178
    v_and_b32 v93, 0xffff0000, v178
    v_lshlrev_b32 v94, 16, v179
    v_and_b32 v95, 0xffff0000, v179
    v_mul_f32 v88, v88, v80
    v_mul_f32 v89, v89, v81
    v_mul_f32 v90, v90, v82
    v_mul_f32 v91, v91, v83
    v_mul_f32 v92, v92, v84
    v_mul_f32 v93, v93, v85
    v_mul_f32 v94, v94, v86
    v_mul_f32 v95, v95, v87
    v_cvt_pk_bf16_f32 v176, v88, v89
    v_cvt_pk_bf16_f32 v177, v90, v91
    v_cvt_pk_bf16_f32 v178, v92, v93
    v_cvt_pk_bf16_f32 v179, v94, v95
    buffer_store_dwordx4 v[176:179], v112, s[20:23], s41 offen
    s_waitcnt vmcnt(0)
g2_done:
    s_endpgm
g2_late:
    v_lshlrev_b32 v2, 1, v6
    buffer_load_ushort v4, v2, s[44:47], 0 offen
    buffer_load_ushort v5, v2, s[44:47], 0 offen offset:32
    v_add_u32 v8, 0, v1
    v_mul_u32_u24 v2, 3641, v8
    v_lshrrev_b32 v2, 16, v2
    v_mul_u32_u24 v3, 18, v2
    v_sub_u32 v3, v8, v3
    v_mul_u32_u24 v8, 9216, v2
    v_lshl_add_u32 v8, v3, 4, v8
    buffer_load_dwordx4 v[144:147], v8, s[24:27], s40 offen
    v_add_u32 v8, 64, v1
    v_mul_u32_u24 v2, 3641, v8
    v_lshrrev_b32 v2, 16, v2
    v_mul_u32_u24 v3, 18, v2
    v_sub_u32 v3, v8, v3
    v_mul_u32_u24 v8, 9216, v2
    v_lshl_add_u32 v8, v3, 4, v8
    buffer_load_dwordx4 v[148:151], v8, s[24:27], s40 offen
    v_add_u32 v8, 128, v1
    v_mul_u32_u24 v2, 3641, v8
    v_lshrrev_b32 v2, 16, v2
    v_mul_u32_u24 v3, 18, v2
    v_sub_u32 v3, v8, v3
    v_mul_u32_u24 v8, 9216, v2
    v_lshl_add_u32 v8, v3, 4, v8
    buffer_load_dwordx4 v[152:155], v8, s[24:27], s40 offen
    v_add_u32 v8, 192, v1
    v_mul_u32_u24 v2, 3641, v8
    v_lshrrev_b32 v2, 16, v2
    v_mul_u32_u24 v3, 18, v2
    v_sub_u32 v3, v8, v3
    v_mul_u32_u24 v8, 9216, v2
    v_lshl_add_u32 v8, v3, 4, v8
    buffer_load_dwordx4 v[156:159], v8, s[24:27], s40 offen
    v_add_u32 v8, 256, v1
    v_mul_u32_u24 v2, 3641, v8
    v_lshrrev_b32 v2, 16, v2
    v_mul_u32_u24 v3, 18, v2
    v_sub_u32 v3, v8, v3
    v_mul_u32_u24 v8, 9216, v2
    v_lshl_add_u32 v8, v3, 4, v8
    buffer_load_dwordx4 v[160:163], v8, s[24:27], s40 offen
    v_add_u32 v8, 320, v1
    v_mul_u32_u24 v2, 3641, v8
    v_lshrrev_b32 v2, 16, v2
    v_mul_u32_u24 v3, 18, v2
    v_sub_u32 v3, v8, v3
    v_mul_u32_u24 v8, 9216, v2
    v_lshl_add_u32 v8, v3, 4, v8
    buffer_load_dwordx4 v[164:167], v8, s[24:27], s40 offen
    v_add_u32 v8, 384, v1
    v_mul_u32_u24 v2, 3641, v8
    v_lshrrev_b32 v2, 16, v2
    v_mul_u32_u24 v3, 18, v2
    v_sub_u32 v3, v8, v3
    v_mul_u32_u24 v8, 9216, v2
    v_lshl_add_u32 v8, v3, 4, v8
    buffer_load_dwordx4 v[168:171], v8, s[24:27], s40 offen
    v_add_u32 v8, 448, v1
    v_mul_u32_u24 v2, 3641, v8
    v_lshrrev_b32 v2, 16, v2
    v_mul_u32_u24 v3, 18, v2
    v_sub_u32 v3, v8, v3
    v_mul_u32_u24 v8, 9216, v2
    v_lshl_add_u32 v8, v3, 4, v8
    buffer_load_dwordx4 v[172:175], v8, s[24:27], s40 offen
    v_add_u32 v8, 512, v1
    v_mul_u32_u24 v2, 3641, v8
    v_lshrrev_b32 v2, 16, v2
    v_mul_u32_u24 v3, 18, v2
    v_sub_u32 v3, v8, v3
    v_mul_u32_u24 v8, 9216, v2
    v_lshl_add_u32 v8, v3, 4, v8
    buffer_load_dwordx4 v[176:179], v8, s[24:27], s40 offen
    s_branch g2_lateback
g2_loader:
    s_setprio 3
    s_cmp_eq_u32 s30, 5
    s_cbranch_scc1 g2_loaderA
    s_mov_b32 s33, 0
    v_lshlrev_b32 v4, 4, v1
    s_mov_b32 s34, 0
    s_mov_b32 s39, 4
g2_lpre:
    s_add_u32 m0, s34, 65536
    s_add_u32 s36, s33, 0
    buffer_load_dwordx4 v4, s[16:19], s36 offen lds
    s_add_u32 m0, s34, 66560
    s_add_u32 s36, s33, 1024
    buffer_load_dwordx4 v4, s[16:19], s36 offen lds
    s_add_u32 m0, s34, 67584
    s_add_u32 s36, s33, 2048
    buffer_load_dwordx4 v4, s[16:19], s36 offen lds
    s_add_u32 m0, s34, 68608
    s_add_u32 s36, s33, 3072
    buffer_load_dwordx4 v4, s[16:19], s36 offen lds
    s_add_u32 m0, s34, 69632
    s_add_u32 s36, s33, 4096
    buffer_load_dwordx4 v4, s[16:19], s36 offen lds
    s_add_u32 m0, s34, 70656
    s_add_u32 s36, s33, 5120
    buffer_load_dwordx4 v4, s[16:19], s36 offen lds
    s_add_u32 m0, s34, 71680
    s_add_u32 s36, s33, 6144
    buffer_load_dwordx4 v4, s[16:19], s36 offen lds
    s_add_u32 m0, s34, 72704
    s_add_u32 s36, s33, 7168
    buffer_load_dwordx4 v4, s[16:19], s36 offen lds
    s_add_u32 m0, s34, 73728
    s_add_u32 s36, s33, 8192
    buffer_load_dwordx4 v4, s[16:19], s36 offen lds
    s_add_u32 s33, s33, 9216
    s_add_u32 s34, s34, 9216
    s_cmp_eq_u32 s34, 73728
    s_cselect_b32 s34, 0, s34
    s_sub_u32 s39, s39, 1
    s_cmp_lg_u32 s39, 0
    s_cbranch_scc1 g2_lpre
    s_mov_b32 s39, 32
g2_lloopB:
    s_waitcnt vmcnt(18)
    s_barrier
    s_add_u32 m0, s34, 65536
    s_add_u32 s36, s33, 0
    buffer_load_dwordx4 v4, s[16:19], s36 offen lds
    s_add_u32 m0, s34, 66560
    s_add_u32 s36, s33, 1024
    buffer_load_dwordx4 v4, s[16:19], s36 offen lds
    s_add_u32 m0, s34, 67584
    s_add_u32 s36, s33, 2048
    buffer_load_dwordx4 v4, s[16:19], s36 offen lds
    s_add_u32 m0, s34, 68608
    s_add_u32 s36, s33, 3072
    buffer_load_dwordx4 v4, s[16:19], s36 offen lds
    s_add_u32 m0, s34, 69632
    s_add_u32 s36, s33, 4096
    buffer_load_dwordx4 v4, s[16:19], s36 offen lds
    s_add_u32 m0, s34, 70656
    s_add_u32 s36, s33, 5120
    buffer_load_dwordx4 v4, s[16:19], s36 offen lds
    s_add_u32 m0, s34, 71680
    s_add_u32 s36, s33, 6144
    buffer_load_dwordx4 v4, s[16:19], s36 offen lds
    s_add_u32 m0, s34, 72704
    s_add_u32 s36, s33, 7168
    buffer_load_dwordx4 v4, s[16:19], s36 offen lds
    s_add_u32 m0, s34, 73728
    s_add_u32 s36, s33, 8192
    buffer_load_dwordx4 v4, s[16:19], s36 offen lds
    s_add_u32 s33, s33, 9216
    s_add_u32 s34, s34, 9216
    s_cmp_eq_u32 s34, 73728
    s_cselect_b32 s34, 0, s34
    s_add_u32 m0, s34, 65536
    s_add_u32 s36, s33, 0
    buffer_load_dwordx4 v4, s[16:19], s36 offen lds
    s_add_u32 m0, s34, 66560
    s_add_u32 s36, s33, 1024
    buffer_load_dwordx4 v4, s[16:19], s36 offen lds
    s_add_u32 m0, s34, 67584
    s_add_u32 s36, s33, 2048
    buffer_load_dwordx4 v4, s[16:19], s36 offen lds
    s_add_u32 m0, s34, 68608
    s_add_u32 s36, s33, 3072
    buffer_load_dwordx4 v4, s[16:19], s36 offen lds
    s_add_u32 m0, s34, 69632
    s_add_u32 s36, s33, 4096
    buffer_load_dwordx4 v4, s[16:19], s36 offen lds
    s_add_u32 m0, s34, 70656
    s_add_u32 s36, s33, 5120
    buffer_load_dwordx4 v4, s[16:19], s36 offen lds
    s_add_u32 m0, s34, 71680
    s_add_u32 s36, s33, 6144
    buffer_load_dwordx4 v4, s[16:19], s36 offen lds
    s_add_u32 m0, s34, 72704
    s_add_u32 s36, s33, 7168
    buffer_load_dwordx4 v4, s[16:19], s36 offen lds
    s_add_u32 m0, s34, 73728
    s_add_u32 s36, s33, 8192
    buffer_load_dwordx4 v4, s[16:19], s36 offen lds
    s_add_u32 s33, s33, 9216
    s_add_u32 s34, s34, 9216
    s_cmp_eq_u32 s34, 73728
    s_cselect_b32 s34, 0, s34
    s_sub_u32 s39, s39, 1
    s_cmp_lg_u32 s39, 0
    s_cbranch_scc1 g2_lloopB
    s_waitcnt vmcnt(0)
    s_barrier
    s_endpgm
g2_loaderA:
    v_lshrrev_b32 v3, 3, v1
    v_and_b32 v4, 7, v1
    v_xor_b32 v4, v4, v3
    s_mul_i32 s36, s28, 128
    v_add_u32 v3, s36, v3
    s_mov_b32 s37, 4096
    v_mul_lo_u32 v2, v3, s37
    v_lshl_add_u32 v2, v4, 4, v2
    s_mov_b32 s32, 0
    s_mov_b32 s34, 0

    s_mov_b32 s39, 2
g2_lpreA:
    s_add_u32 s36, s32, 0
    s_add_u32 m0, s34, 0
    s_nop 0
    buffer_load_dwordx4 v2, s[12:15], s36 offen lds
    s_add_u32 s36, s32, 32768
    s_add_u32 m0, s34, 1024
    s_nop 0
    buffer_load_dwordx4 v2, s[12:15], s36 offen lds
    s_add_u32 s36, s32, 65536
    s_add_u32 m0, s34, 2048
    s_nop 0
    buffer_load_dwordx4 v2, s[12:15], s36 offen lds
    s_add_u32 s36, s32, 98304
    s_add_u32 m0, s34, 3072
    s_nop 0
    buffer_load_dwordx4 v2, s[12:15], s36 offen lds
    s_add_u32 s36, s32, 131072
    s_add_u32 m0, s34, 4096
    s_nop 0
    buffer_load_dwordx4 v2, s[12:15], s36 offen lds
    s_add_u32 s36, s32, 163840
    s_add_u32 m0, s34, 5120
    s_nop 0
    buffer_load_dwordx4 v2, s[12:15], s36 offen lds
    s_add_u32 s36, s32, 196608
    s_add_u32 m0, s34, 6144
    s_nop 0
    buffer_load_dwordx4 v2, s[12:15], s36 offen lds
    s_add_u32 s36, s32, 229376
    s_add_u32 m0, s34, 7168
    s_nop 0
    buffer_load_dwordx4 v2, s[12:15], s36 offen lds
    s_add_u32 s36, s32, 262144
    s_add_u32 m0, s34, 8192
    s_nop 0
    buffer_load_dwordx4 v2, s[12:15], s36 offen lds
    s_add_u32 s36, s32, 294912
    s_add_u32 m0, s34, 9216
    s_nop 0
    buffer_load_dwordx4 v2, s[12:15], s36 offen lds
    s_add_u32 s36, s32, 327680
    s_add_u32 m0, s34, 10240
    s_nop 0
    buffer_load_dwordx4 v2, s[12:15], s36 offen lds
    s_add_u32 s36, s32, 360448
    s_add_u32 m0, s34, 11264
    s_nop 0
    buffer_load_dwordx4 v2, s[12:15], s36 offen lds
    s_add_u32 s36, s32, 393216
    s_add_u32 m0, s34, 12288
    s_nop 0
    buffer_load_dwordx4 v2, s[12:15], s36 offen lds
    s_add_u32 s36, s32, 425984
    s_add_u32 m0, s34, 13312
    s_nop 0
    buffer_load_dwordx4 v2, s[12:15], s36 offen lds
    s_add_u32 s36, s32, 458752
    s_add_u32 m0, s34, 14336
    s_nop 0
    buffer_load_dwordx4 v2, s[12:15], s36 offen lds
    s_add_u32 s36, s32, 491520
    s_add_u32 m0, s34, 15360
    s_nop 0
    buffer_load_dwordx4 v2, s[12:15], s36 offen lds
    s_add_u32 s32, s32, 128
    s_add_u32 s34, s34, 16384
    s_cmp_eq_u32 s34, 65536
    s_cselect_b32 s34, 0, s34
    s_sub_u32 s39, s39, 1
    s_cmp_lg_u32 s39, 0
    s_cbranch_scc1 g2_lpreA
    s_mov_b32 s39, 32
g2_lloopA:
    s_waitcnt vmcnt(16)
    s_barrier
    s_add_u32 s36, s32, 0
    s_add_u32 m0, s34, 0
    s_nop 0
    buffer_load_dwordx4 v2, s[12:15], s36 offen lds
    s_add_u32 s36, s32, 32768
    s_add_u32 m0, s34, 1024
    s_nop 0
    buffer_load_dwordx4 v2, s[12:15], s36 offen lds
    s_add_u32 s36, s32, 65536
    s_add_u32 m0, s34, 2048
    s_nop 0
    buffer_load_dwordx4 v2, s[12:15], s36 offen lds
    s_add_u32 s36, s32, 98304
    s_add_u32 m0, s34, 3072
    s_nop 0
    buffer_load_dwordx4 v2, s[12:15], s36 offen lds
    s_add_u32 s36, s32, 131072
    s_add_u32 m0, s34, 4096
    s_nop 0
    buffer_load_dwordx4 v2, s[12:15], s36 offen lds
    s_add_u32 s36, s32, 163840
    s_add_u32 m0, s34, 5120
    s_nop 0
    buffer_load_dwordx4 v2, s[12:15], s36 offen lds
    s_add_u32 s36, s32, 196608
    s_add_u32 m0, s34, 6144
    s_nop 0
    buffer_load_dwordx4 v2, s[12:15], s36 offen lds
    s_add_u32 s36, s32, 229376
    s_add_u32 m0, s34, 7168
    s_nop 0
    buffer_load_dwordx4 v2, s[12:15], s36 offen lds
    s_add_u32 s36, s32, 262144
    s_add_u32 m0, s34, 8192
    s_nop 0
    buffer_load_dwordx4 v2, s[12:15], s36 offen lds
    s_add_u32 s36, s32, 294912
    s_add_u32 m0, s34, 9216
    s_nop 0
    buffer_load_dwordx4 v2, s[12:15], s36 offen lds
    s_add_u32 s36, s32, 327680
    s_add_u32 m0, s34, 10240
    s_nop 0
    buffer_load_dwordx4 v2, s[12:15], s36 offen lds
    s_add_u32 s36, s32, 360448
    s_add_u32 m0, s34, 11264
    s_nop 0
    buffer_load_dwordx4 v2, s[12:15], s36 offen lds
    s_add_u32 s36, s32, 393216
    s_add_u32 m0, s34, 12288
    s_nop 0
    buffer_load_dwordx4 v2, s[12:15], s36 offen lds
    s_add_u32 s36, s32, 425984
    s_add_u32 m0, s34, 13312
    s_nop 0
    buffer_load_dwordx4 v2, s[12:15], s36 offen lds
    s_add_u32 s36, s32, 458752
    s_add_u32 m0, s34, 14336
    s_nop 0
    buffer_load_dwordx4 v2, s[12:15], s36 offen lds
    s_add_u32 s36, s32, 491520
    s_add_u32 m0, s34, 15360
    s_nop 0
    buffer_load_dwordx4 v2, s[12:15], s36 offen lds
    s_add_u32 s32, s32, 128
    s_add_u32 s34, s34, 16384
    s_cmp_eq_u32 s34, 65536
    s_cselect_b32 s34, 0, s34
    s_sub_u32 s39, s39, 1
    s_cmp_lg_u32 s39, 0
    s_cbranch_scc1 g2_lloopA
    s_waitcnt vmcnt(0)
    s_barrier
    s_endpgm
.section .rodata,"a"
.p2align 6
.amdhsa_kernel gemm2_kernel
  .amdhsa_next_free_vgpr 180
  .amdhsa_next_free_sgpr 60
  .amdhsa_accum_offset 180
  .amdhsa_group_segment_fixed_size 0
  .amdhsa_kernarg_size 104
  .amdhsa_user_sgpr_count 2
  .amdhsa_user_sgpr_kernarg_segment_ptr 1
  .amdhsa_system_sgpr_workgroup_id_x 1
.end_amdhsa_kernel
.text
.globl gemm3_kernel
.p2align 8
.type gemm3_kernel,@function
gemm3_kernel:
    s_load_dwordx2 s[4:5], s[0:1], 32
    s_load_dwordx2 s[6:7], s[0:1], 72
    s_load_dwordx2 s[8:9], s[0:1], 0
    s_load_dwordx2 s[10:11], s[0:1], 96
    s_load_dwordx2 s[48:49], s[0:1], 80
    s_cmp_ge_u32 s2, 192
    s_cbranch_scc1 g3_done
    s_and_b32 s36, s2, 7
    s_lshr_b32 s37, s2, 3
    s_mul_i32 s38, s37, 43
    s_lshr_b32 s38, s38, 8
    s_mul_i32 s29, s38, 6
    s_sub_u32 s29, s37, s29
    s_lshl_b32 s28, s36, 2
    s_add_u32 s28, s28, s38
    v_lshrrev_b32 v1, 6, v0
    s_nop 0
    v_readfirstlane_b32 s30, v1
    v_and_b32 v1, 63, v0
    s_waitcnt lgkmcnt(0)

    s_add_u32 s12, s10, 0x1700000
    s_addc_u32 s13, s11, 0
    s_and_b32 s13, s13, 0xffff
    s_mov_b32 s14, 0xb40000
    s_mov_b32 s15, 0x00020000
    s_mul_i32 s36, s29, 192
    s_sub_u32 s37, 663552, s36
    s_add_u32 s16, s4, s36
    s_addc_u32 s17, s5, 0
    s_and_b32 s17, s17, 0xffff
    s_mov_b32 s18, s37
    s_mov_b32 s19, 0x00020000
    s_sub_u32 s37, 2654208, s36
    s_add_u32 s24, s6, s36
    s_addc_u32 s25, s7, 0
    s_and_b32 s25, s25, 0xffff
    s_mov_b32 s26, s37
    s_mov_b32 s27, 0x00020000
    s_sub_u32 s37, 2359296, s36
    s_add_u32 s20, s48, s36
    s_addc_u32 s21, s49, 0
    s_and_b32 s21, s21, 0xffff
    s_mov_b32 s22, s37
    s_mov_b32 s23, 0x00020000
    s_add_u32 s44, s8, s36
    s_addc_u32 s45, s9, 0
    s_and_b32 s45, s45, 0xffff
    s_mov_b32 s46, s37
    s_mov_b32 s47, 0x00020000
    s_cmp_ge_u32 s30, 4
    s_cbranch_scc1 g3_loader
    s_and_b32 s31, s30, 1
    s_lshr_b32 s43, s30, 1
    s_mul_i32 s43, s43, 3
    v_and_b32 v6, 15, v1
    v_lshrrev_b32 v7, 4, v1
    v_lshrrev_b32 v2, 2, v1
    v_mul_u32_u24 v2, 192, v2
    v_and_b32 v3, 3, v1
    v_lshl_add_u32 v2, v3, 3, v2
    v_add_u32 v2, 49152, v2
    v_and_b32 v3, 1, v7

    s_add_u32 s36, s43, 0
    v_xor_b32 v4, s36, v3
    v_lshl_add_u32 v80, v4, 5, v2
    v_mov_b32 v83, v80
    s_add_u32 s36, s43, 1
    v_xor_b32 v4, s36, v3
    v_lshl_add_u32 v81, v4, 5, v2
    v_mov_b32 v84, v81
    s_add_u32 s36, s43, 2
    v_xor_b32 v4, s36, v3
    v_lshl_add_u32 v82, v4, 5, v2
    v_mov_b32 v85, v82
    s_lshl_b32 s36, s31, 12
    v_add_u32 v3, 0, v7
    v_and_b32 v2, 7, v6
    v_xor_b32 v3, v3, v2
    v_lshlrev_b32 v3, 4, v3
    v_lshl_add_u32 v3, v6, 7, v3
    v_add_u32 v86, s36, v3
    v_add_u32 v3, 4, v7
    v_and_b32 v2, 7, v6
    v_xor_b32 v3, v3, v2
    v_lshlrev_b32 v3, 4, v3
    v_lshl_add_u32 v3, v6, 7, v3
    v_add_u32 v87, s36, v3
    s_lshl_b32 s36, s28, 6
    s_lshl_b32 s37, s31, 5
    s_add_u32 s36, s36, s37
    v_add_u32 v6, s36, v6
    s_mov_b32 s32, 0
    s_mov_b32 s33, 0
    s_mov_b32 s34, 0
    s_mov_b32 s35, 0
    s_mov_b32 s39, 45
    s_mov_b32 s36, 1152
    v_mul_lo_u32 v8, v6, s36
    v_lshl_add_u32 v8, v7, 3, v8
    v_add_u32 v9, 18432, v8
    s_lshl_b32 s42, s43, 5

    buffer_load_dwordx2 v[88:89], v8, s[44:47], s42 offen offset:0
    buffer_load_dwordx2 v[90:91], v8, s[44:47], s42 offen offset:32
    buffer_load_dwordx2 v[92:93], v8, s[44:47], s42 offen offset:64
    buffer_load_dwordx2 v[94:95], v9, s[44:47], s42 offen offset:0
    buffer_load_dwordx2 v[96:97], v9, s[44:47], s42 offen offset:32
    buffer_load_dwordx2 v[98:99], v9, s[44:47], s42 offen offset:64
    v_mov_b32 v16, 0
    v_mov_b32 v17, 0
    v_mov_b32 v18, 0
    v_mov_b32 v19, 0
    v_mov_b32 v20, 0
    v_mov_b32 v21, 0
    v_mov_b32 v22, 0
    v_mov_b32 v23, 0
    v_mov_b32 v24, 0
    v_mov_b32 v25, 0
    v_mov_b32 v26, 0
    v_mov_b32 v27, 0
    v_mov_b32 v28, 0
    v_mov_b32 v29, 0
    v_mov_b32 v30, 0
    v_mov_b32 v31, 0
    v_mov_b32 v32, 0
    v_mov_b32 v33, 0
    v_mov_b32 v34, 0
    v_mov_b32 v35, 0
    v_mov_b32 v36, 0
    v_mov_b32 v37, 0
    v_mov_b32 v38, 0
    v_mov_b32 v39, 0
    s_barrier
    ds_read_b128 v[40:43], v86 offset:0
    ds_read_b128 v[44:47], v86 offset:2048
    ds_read_b64_tr_b16 v[56:57], v80
    ds_read_b64_tr_b16 v[58:59], v80 offset:3072
    ds_read_b64_tr_b16 v[60:61], v81
    ds_read_b64_tr_b16 v[62:63], v81 offset:3072
    ds_read_b64_tr_b16 v[64:65], v82
    ds_read_b64_tr_b16 v[66:67], v82 offset:3072
g3_loop:
    s_add_u32 s34, s34, 6144
    s_cmp_eq_u32 s34, 73728
    s_cselect_b32 s34, 0, s34
    s_sub_u32 s36, s34, s33
    s_mov_b32 s33, s34
    v_add_u32 v83, s36, v83
    v_add_u32 v84, s36, v84
    v_add_u32 v85, s36, v85
    ds_read_b128 v[48:51], v87 offset:0
    ds_read_b128 v[52:55], v87 offset:2048
    s_waitcnt lgkmcnt(8)
    s_waitcnt lgkmcnt(6)
    v_mfma_f32_16x16x32_bf16 v[16:19], v[56:59], v[40:43], v[16:19]
    ds_read_b64_tr_b16 v[68:69], v83
    ds_read_b64_tr_b16 v[70:71], v83 offset:3072
    v_mfma_f32_16x16x32_bf16 v[28:31], v[56:59], v[44:47], v[28:31]
    s_waitcnt lgkmcnt(6)
    v_mfma_f32_16x16x32_bf16 v[20:23], v[60:63], v[40:43], v[20:23]
    ds_read_b64_tr_b16 v[72:73], v84
    ds_read_b64_tr_b16 v[74:75], v84 offset:3072
    v_mfma_f32_16x16x32_bf16 v[32:35], v[60:63], v[44:47], v[32:35]
    s_waitcnt lgkmcnt(6)
    v_mfma_f32_16x16x32_bf16 v[24:27], v[64:67], v[40:43], v[24:27]
    ds_read_b64_tr_b16 v[76:77], v85
    ds_read_b64_tr_b16 v[78:79], v85 offset:3072
    v_mfma_f32_16x16x32_bf16 v[36:39], v[64:67], v[44:47], v[36:39]
    s_add_u32 s34, s34, 6144
    s_cmp_eq_u32 s34, 73728
    s_cselect_b32 s34, 0, s34
    s_sub_u32 s36, s34, s32
    s_mov_b32 s32, s34
    v_add_u32 v80, s36, v80
    v_add_u32 v81, s36, v81
    v_add_u32 v82, s36, v82
    s_add_u32 s37, s35, 8192
    s_cmp_eq_u32 s37, 49152
    s_cselect_b32 s37, 0, s37
    s_sub_u32 s38, s37, s35
    s_mov_b32 s35, s37
    v_add_u32 v86, s38, v86
    s_barrier
    ds_read_b128 v[40:43], v86 offset:0
    ds_read_b128 v[44:47], v86 offset:2048
    v_add_u32 v87, s38, v87
    s_waitcnt lgkmcnt(8)
    s_waitcnt lgkmcnt(6)
    v_mfma_f32_16x16x32_bf16 v[16:19], v[68:71], v[48:51], v[16:19]
    ds_read_b64_tr_b16 v[56:57], v80
    ds_read_b64_tr_b16 v[58:59], v80 offset:3072
    v_mfma_f32_16x16x32_bf16 v[28:31], v[68:71], v[52:55], v[28:31]
    s_waitcnt lgkmcnt(6)
    v_mfma_f32_16x16x32_bf16 v[20:23], v[72:75], v[48:51], v[20:23]
    ds_read_b64_tr_b16 v[60:61], v81
    ds_read_b64_tr_b16 v[62:63], v81 offset:3072
    v_mfma_f32_16x16x32_bf16 v[32:35], v[72:75], v[52:55], v[32:35]
    s_waitcnt lgkmcnt(6)
    v_mfma_f32_16x16x32_bf16 v[24:27], v[76:79], v[48:51], v[24:27]
    ds_read_b64_tr_b16 v[64:65], v82
    ds_read_b64_tr_b16 v[66:67], v82 offset:3072
    v_mfma_f32_16x16x32_bf16 v[36:39], v[76:79], v[52:55], v[36:39]
    s_sub_u32 s39, s39, 1
    s_cmp_lg_u32 s39, 0
    s_cbranch_scc1 g3_loop
    s_waitcnt lgkmcnt(0) vmcnt(0)
    s_nop 7
    v_lshlrev_b32 v40, 16, v88
    v_and_b32 v41, 0xffff0000, v88
    v_lshlrev_b32 v42, 16, v89
    v_and_b32 v43, 0xffff0000, v89
    v_add_f32 v40, v40, v16
    v_add_f32 v41, v41, v17
    v_add_f32 v42, v42, v18
    v_add_f32 v43, v43, v19
    v_cvt_pk_bf16_f32 v44, v40, v41
    v_cvt_pk_bf16_f32 v45, v42, v43
    buffer_store_dwordx2 v[44:45], v8, s[20:23], s42 offen offset:0
    v_lshlrev_b32 v48, 16, v90
    v_and_b32 v49, 0xffff0000, v90
    v_lshlrev_b32 v50, 16, v91
    v_and_b32 v51, 0xffff0000, v91
    v_add_f32 v48, v48, v20
    v_add_f32 v49, v49, v21
    v_add_f32 v50, v50, v22
    v_add_f32 v51, v51, v23
    v_cvt_pk_bf16_f32 v52, v48, v49
    v_cvt_pk_bf16_f32 v53, v50, v51
    buffer_store_dwordx2 v[52:53], v8, s[20:23], s42 offen offset:32
    v_lshlrev_b32 v40, 16, v92
    v_and_b32 v41, 0xffff0000, v92
    v_lshlrev_b32 v42, 16, v93
    v_and_b32 v43, 0xffff0000, v93
    v_add_f32 v40, v40, v24
    v_add_f32 v41, v41, v25
    v_add_f32 v42, v42, v26
    v_add_f32 v43, v43, v27
    v_cvt_pk_bf16_f32 v44, v40, v41
    v_cvt_pk_bf16_f32 v45, v42, v43
    buffer_store_dwordx2 v[44:45], v8, s[20:23], s42 offen offset:64
    v_lshlrev_b32 v48, 16, v94
    v_and_b32 v49, 0xffff0000, v94
    v_lshlrev_b32 v50, 16, v95
    v_and_b32 v51, 0xffff0000, v95
    v_add_f32 v48, v48, v28
    v_add_f32 v49, v49, v29
    v_add_f32 v50, v50, v30
    v_add_f32 v51, v51, v31
    v_cvt_pk_bf16_f32 v52, v48, v49
    v_cvt_pk_bf16_f32 v53, v50, v51
    buffer_store_dwordx2 v[52:53], v9, s[20:23], s42 offen offset:0
    v_lshlrev_b32 v40, 16, v96
    v_and_b32 v41, 0xffff0000, v96
    v_lshlrev_b32 v42, 16, v97
    v_and_b32 v43, 0xffff0000, v97
    v_add_f32 v40, v40, v32
    v_add_f32 v41, v41, v33
    v_add_f32 v42, v42, v34
    v_add_f32 v43, v43, v35
    v_cvt_pk_bf16_f32 v44, v40, v41
    v_cvt_pk_bf16_f32 v45, v42, v43
    buffer_store_dwordx2 v[44:45], v9, s[20:23], s42 offen offset:32
    v_lshlrev_b32 v48, 16, v98
    v_and_b32 v49, 0xffff0000, v98
    v_lshlrev_b32 v50, 16, v99
    v_and_b32 v51, 0xffff0000, v99
    v_add_f32 v48, v48, v36
    v_add_f32 v49, v49, v37
    v_add_f32 v50, v50, v38
    v_add_f32 v51, v51, v39
    v_cvt_pk_bf16_f32 v52, v48, v49
    v_cvt_pk_bf16_f32 v53, v50, v51
    buffer_store_dwordx2 v[52:53], v9, s[20:23], s42 offen offset:64
g3_done:
    s_endpgm
g3_loader:
    s_setprio 3
    s_cmp_eq_u32 s30, 5
    s_cbranch_scc1 g3_loaderA
    v_lshlrev_b32 v4, 4, v1
    s_add_u32 s52, s10, 0x2c00000
    s_addc_u32 s53, s11, 0
    s_and_b32 s53, s53, 0xffff
    s_mov_b32 s54, 0x32a000
    s_mov_b32 s55, 0x00020000
    s_mul_i32 s33, s29, 552960
    s_mov_b32 s34, 0
    s_mov_b32 s39, 4
g3_lpreB:
    s_add_u32 m0, s34, 49152
    s_add_u32 s56, s33, 0
    buffer_load_dwordx4 v4, s[52:55], s56 offen lds
    s_add_u32 m0, s34, 50176
    s_add_u32 s56, s33, 1024
    buffer_load_dwordx4 v4, s[52:55], s56 offen lds
    s_add_u32 m0, s34, 51200
    s_add_u32 s56, s33, 2048
    buffer_load_dwordx4 v4, s[52:55], s56 offen lds
    s_add_u32 m0, s34, 52224
    s_add_u32 s56, s33, 3072
    buffer_load_dwordx4 v4, s[52:55], s56 offen lds
    s_add_u32 m0, s34, 53248
    s_add_u32 s56, s33, 4096
    buffer_load_dwordx4 v4, s[52:55], s56 offen lds
    s_add_u32 m0, s34, 54272
    s_add_u32 s56, s33, 5120
    buffer_load_dwordx4 v4, s[52:55], s56 offen lds
    s_add_u32 m0, s34, 55296
    s_add_u32 s56, s33, 6144
    buffer_load_dwordx4 v4, s[52:55], s56 offen lds
    s_add_u32 m0, s34, 56320
    s_add_u32 s56, s33, 7168
    buffer_load_dwordx4 v4, s[52:55], s56 offen lds
    s_add_u32 m0, s34, 57344
    s_add_u32 s56, s33, 8192
    buffer_load_dwordx4 v4, s[52:55], s56 offen lds
    s_add_u32 m0, s34, 58368
    s_add_u32 s56, s33, 9216
    buffer_load_dwordx4 v4, s[52:55], s56 offen lds
    s_add_u32 m0, s34, 59392
    s_add_u32 s56, s33, 10240
    buffer_load_dwordx4 v4, s[52:55], s56 offen lds
    s_add_u32 m0, s34, 60416
    s_add_u32 s56, s33, 11264
    buffer_load_dwordx4 v4, s[52:55], s56 offen lds
    s_add_u32 s33, s33, 12288
    s_add_u32 s34, s34, 12288
    s_cmp_eq_u32 s34, 73728
    s_cselect_b32 s34, 0, s34
    s_sub_u32 s39, s39, 1
    s_cmp_lg_u32 s39, 0
    s_cbranch_scc1 g3_lpreB
    s_mov_b32 s39, 45
g3_lloopB:
    s_waitcnt vmcnt(36)
    s_barrier
    s_add_u32 m0, s34, 49152
    s_add_u32 s56, s33, 0
    buffer_load_dwordx4 v4, s[52:55], s56 offen lds
    s_add_u32 m0, s34, 50176
    s_add_u32 s56, s33, 1024
    buffer_load_dwordx4 v4, s[52:55], s56 offen lds
    s_add_u32 m0, s34, 51200
    s_add_u32 s56, s33, 2048
    buffer_load_dwordx4 v4, s[52:55], s56 offen lds
    s_add_u32 m0, s34, 52224
    s_add_u32 s56, s33, 3072
    buffer_load_dwordx4 v4, s[52:55], s56 offen lds
    s_add_u32 m0, s34, 53248
    s_add_u32 s56, s33, 4096
    buffer_load_dwordx4 v4, s[52:55], s56 offen lds
    s_add_u32 m0, s34, 54272
    s_add_u32 s56, s33, 5120
    buffer_load_dwordx4 v4, s[52:55], s56 offen lds
    s_add_u32 m0, s34, 55296
    s_add_u32 s56, s33, 6144
    buffer_load_dwordx4 v4, s[52:55], s56 offen lds
    s_add_u32 m0, s34, 56320
    s_add_u32 s56, s33, 7168
    buffer_load_dwordx4 v4, s[52:55], s56 offen lds
    s_add_u32 m0, s34, 57344
    s_add_u32 s56, s33, 8192
    buffer_load_dwordx4 v4, s[52:55], s56 offen lds
    s_add_u32 m0, s34, 58368
    s_add_u32 s56, s33, 9216
    buffer_load_dwordx4 v4, s[52:55], s56 offen lds
    s_add_u32 m0, s34, 59392
    s_add_u32 s56, s33, 10240
    buffer_load_dwordx4 v4, s[52:55], s56 offen lds
    s_add_u32 m0, s34, 60416
    s_add_u32 s56, s33, 11264
    buffer_load_dwordx4 v4, s[52:55], s56 offen lds
    s_add_u32 s33, s33, 12288
    s_add_u32 s34, s34, 12288
    s_cmp_eq_u32 s34, 73728
    s_cselect_b32 s34, 0, s34
    s_sub_u32 s39, s39, 1
    s_cmp_lg_u32 s39, 0
    s_cbranch_scc1 g3_lloopB
    s_waitcnt vmcnt(0)
    s_barrier
    s_endpgm
g3_loaderA:
    v_lshrrev_b32 v3, 3, v1
    v_and_b32 v4, 7, v1
    v_xor_b32 v4, v4, v3
    s_lshl_b32 s36, s28, 6
    v_add_u32 v3, s36, v3
    s_mov_b32 s37, 5760
    v_mul_lo_u32 v2, v3, s37
    v_lshl_add_u32 v2, v4, 4, v2
    s_mov_b32 s32, 0
    s_mov_b32 s34, 0

    s_mov_b32 s39, 4
g3_lpreA:
    s_add_u32 s36, s32, 0
    s_add_u32 m0, s34, 0
    s_nop 0
    buffer_load_dwordx4 v2, s[12:15], s36 offen lds
    s_add_u32 s36, s32, 46080
    s_add_u32 m0, s34, 1024
    s_nop 0
    buffer_load_dwordx4 v2, s[12:15], s36 offen lds
    s_add_u32 s36, s32, 92160
    s_add_u32 m0, s34, 2048
    s_nop 0
    buffer_load_dwordx4 v2, s[12:15], s36 offen lds
    s_add_u32 s36, s32, 138240
    s_add_u32 m0, s34, 3072
    s_nop 0
    buffer_load_dwordx4 v2, s[12:15], s36 offen lds
    s_add_u32 s36, s32, 184320
    s_add_u32 m0, s34, 4096
    s_nop 0
    buffer_load_dwordx4 v2, s[12:15], s36 offen lds
    s_add_u32 s36, s32, 230400
    s_add_u32 m0, s34, 5120
    s_nop 0
    buffer_load_dwordx4 v2, s[12:15], s36 offen lds
    s_add_u32 s36, s32, 276480
    s_add_u32 m0, s34, 6144
    s_nop 0
    buffer_load_dwordx4 v2, s[12:15], s36 offen lds
    s_add_u32 s36, s32, 322560
    s_add_u32 m0, s34, 7168
    s_nop 0
    buffer_load_dwordx4 v2, s[12:15], s36 offen lds
    s_add_u32 s32, s32, 128
    s_add_u32 s34, s34, 8192
    s_cmp_eq_u32 s34, 49152
    s_cselect_b32 s34, 0, s34
    s_sub_u32 s39, s39, 1
    s_cmp_lg_u32 s39, 0
    s_cbranch_scc1 g3_lpreA
    s_mov_b32 s39, 45
g3_lloopA:
    s_waitcnt vmcnt(24)
    s_barrier
    s_add_u32 s36, s32, 0
    s_add_u32 m0, s34, 0
    s_nop 0
    buffer_load_dwordx4 v2, s[12:15], s36 offen lds
    s_add_u32 s36, s32, 46080
    s_add_u32 m0, s34, 1024
    s_nop 0
    buffer_load_dwordx4 v2, s[12:15], s36 offen lds
    s_add_u32 s36, s32, 92160
    s_add_u32 m0, s34, 2048
    s_nop 0
    buffer_load_dwordx4 v2, s[12:15], s36 offen lds
    s_add_u32 s36, s32, 138240
    s_add_u32 m0, s34, 3072
    s_nop 0
    buffer_load_dwordx4 v2, s[12:15], s36 offen lds
    s_add_u32 s36, s32, 184320
    s_add_u32 m0, s34, 4096
    s_nop 0
    buffer_load_dwordx4 v2, s[12:15], s36 offen lds
    s_add_u32 s36, s32, 230400
    s_add_u32 m0, s34, 5120
    s_nop 0
    buffer_load_dwordx4 v2, s[12:15], s36 offen lds
    s_add_u32 s36, s32, 276480
    s_add_u32 m0, s34, 6144
    s_nop 0
    buffer_load_dwordx4 v2, s[12:15], s36 offen lds
    s_add_u32 s36, s32, 322560
    s_add_u32 m0, s34, 7168
    s_nop 0
    buffer_load_dwordx4 v2, s[12:15], s36 offen lds
    s_add_u32 s32, s32, 128
    s_add_u32 s34, s34, 8192
    s_cmp_eq_u32 s34, 49152
    s_cselect_b32 s34, 0, s34
    s_sub_u32 s39, s39, 1
    s_cmp_lg_u32 s39, 0
    s_cbranch_scc1 g3_lloopA
    s_waitcnt vmcnt(0)
    s_barrier
    s_endpgm
.section .rodata,"a"
.p2align 6
.amdhsa_kernel gemm3_kernel
  .amdhsa_next_free_vgpr 104
  .amdhsa_next_free_sgpr 64
  .amdhsa_accum_offset 104
  .amdhsa_group_segment_fixed_size 0
  .amdhsa_kernarg_size 104
  .amdhsa_user_sgpr_count 2
  .amdhsa_user_sgpr_kernarg_segment_ptr 1
  .amdhsa_system_sgpr_workgroup_id_x 1
.end_amdhsa_kernel
```
